```python
import torch

def _softmax(x, axis=-1):
    return torch.softmax(x, dim=axis)
def _gelu(x):
    return torch.nn.functional.gelu(x, approximate="tanh")
def _silu(x):
    return torch.nn.functional.silu(x)
def _sigmoid(x):
    return torch.sigmoid(x)
def _layernorm(x, axis=-1, eps=1e-5):
    m = x.mean(dim=axis, keepdim=True)
    v = x.var(dim=axis, keepdim=True, unbiased=False)
    return (x - m) / torch.sqrt(v + eps)
def _scatter_add(tgt, idx, src, axis=0):
    return tgt.clone().index_add_(axis, idx, src)
def _segment_sum(src, seg, n):
    out = torch.zeros((n,) + src.shape[1:], dtype=src.dtype)
    return out.index_add_(0, seg, src)
def _pad(x, pw):
    flat = tuple(v for pair in reversed(pw) for v in pair)
    return torch.nn.functional.pad(x, flat)

kernel_name = 'standalone__adm_resblock__diffusion'

def setup_inputs():

    _w = (lambda a: (lambda t: t.to(torch.bfloat16) if t.is_floating_point() else t)(torch.as_tensor(a)))
    B, C, HW, E = 2, 128, 128, 768
    sc = (9.0 * C) ** -0.5
    return {
        "x": _w((lambda *s: torch.randn(*s, dtype=torch.bfloat16) * 0.05)(B, C, HW, HW)),
        "t_emb": _w((lambda *s: torch.randn(*s, dtype=torch.bfloat16) * 0.4)(B, E)),
        "g1": _w(1.0 + 0.1 * (lambda *s: torch.randn(*s, dtype=torch.bfloat16) * 0.4)(C)),
        "be1": _w(0.1 * (lambda *s: torch.randn(*s, dtype=torch.bfloat16) * 0.4)(C)),
        "w1": _w((lambda *s: torch.randn(*s, dtype=torch.bfloat16) * 0.4)(C, C, 3, 3) * sc),
        "w_emb": _w((lambda *s: torch.randn(*s, dtype=torch.bfloat16) * 0.4)(E, C) * (E ** -0.5)),
        "g2": _w(1.0 + 0.1 * (lambda *s: torch.randn(*s, dtype=torch.bfloat16) * 0.4)(C)),
        "be2": _w(0.1 * (lambda *s: torch.randn(*s, dtype=torch.bfloat16) * 0.4)(C)),
        "w2": _w((lambda *s: torch.randn(*s, dtype=torch.bfloat16) * 0.4)(C, C, 3, 3) * sc),
    }

def reference(x, t_emb, g1, be1, w1, w_emb, g2, be2, w2):
    B, C, H, W = x.shape
    G, eps = 4, 1e-5
    def gn(z, gamma, beta):
        zr = z.reshape(B, G, (C // G) * H * W)
        mu = zr.mean(-1).reshape(B, G, 1)
        var = ((zr - mu) ** 2).mean(-1).reshape(B, G, 1)
        zn = ((zr - mu) / torch.sqrt(var + eps)).reshape(B, C, H, W)
        return zn * gamma.reshape(1, C, 1, 1) + beta.reshape(1, C, 1, 1)
    def conv3(z, w):
        zp = _pad(z, ((0, 0), (0, 0), (1, 1), (1, 1)))
        taps = [torch.einsum("bchw,oc->bohw", zp[:, :, i:i+H, j:j+W], w[:, :, i, j]) for i in range(3) for j in range(3)]
        out = taps[0]
        for t in taps[1:]:
            out = out + t
        return out
    h = conv3(_silu(gn(x, g1, be1)), w1)
    emb = _silu(t_emb) @ w_emb
    h = h + emb.reshape(B, C, 1, 1)
    h = conv3(_silu(gn(h, g2, be2)), w2)
    return x + h
```

```asm
; @launch grid=(256,1,1) block=(256,1,1) lds=125184
.amdgcn_target "amdgcn-amd-amdhsa--gfx950"
.text
.globl standalone__adm_resblock__diffusion_kernel
.p2align 8
.type standalone__adm_resblock__diffusion_kernel,@function
standalone__adm_resblock__diffusion_kernel:
    s_cmp_ge_u32 s2, 256
    s_cbranch_scc1 L_end
    s_load_dwordx16 s[16:31], s[0:1], 0
    s_load_dwordx8 s[32:39], s[0:1], 64
    s_load_dwordx2 s[40:41], s[0:1], 0
    s_load_dwordx2 s[44:45], s[0:1], 72
    s_load_dwordx2 s[48:49], s[0:1], 88
    s_getpc_b64 s[14:15]
L_pc:
    s_add_u32 s14, s14, L_main-L_pc-3072
    s_addc_u32 s15, s15, 0
    s_lshr_b32 s7, s2, 3
    s_lshl_b32 s10, s7, 10
    v_lshl_add_u32 v29, v0, 2, s10
    v_min_u32 v29, 0x6fb4, v29
    v_lshrrev_b32 v24, 6, v0
    s_nop 0
    v_readfirstlane_b32 s3, v24
    v_and_b32 v1, 63, v0
    s_bfe_u32 s4, s2, 0x10002
    s_and_b32 s10, s2, 3
    s_lshl_b32 s10, s10, 5
    s_add_u32 s7, s7, s10
    s_lshr_b32 s5, s7, 2
    s_and_b32 s6, s7, 3
    s_lshl_b32 s66, s4, 22
    s_lshl_b32 s10, s3, 20
    s_add_u32 s66, s66, s10
    s_lshl_b32 s10, s5, 10
    s_add_u32 s66, s66, s10
    s_lshl_b32 s10, s6, 6
    s_add_u32 s66, s66, s10
    s_mov_b32 s52, 0
    s_mov_b32 s53, 31680
    s_mov_b32 s54, 63360
    s_mov_b32 s55, 95040
    s_mov_b32 s56, 131072
    s_mov_b32 s57, 162752
    s_mov_b32 s58, 194432
    s_mov_b32 s59, 226112
    v_lshrrev_b32 v184, 4, v1
    v_bfe_u32 v185, v1, 2, 2
    v_and_b32 v182, 3, v1
    v_and_b32 v180, 31, v1
    v_lshrrev_b32 v181, 5, v1
    v_lshlrev_b32 v176, 18, v184
    v_lshl_add_u32 v176, v185, 8, v176
    v_lshl_add_u32 v176, v182, 4, v176
    v_add_u32 v176, s66, v176
    s_mov_b32 s42, 0x800000
    s_mov_b32 s43, 0x20000
    s_mul_i32 s77, s3, 30720
    s_add_u32 s77, s77, 2304
    s_add_u32 m0, s77, 17536
    s_lshl_b32 s10, s3, 5
    v_add_lshl_u32 v28, v180, s10, 1
    s_cmp_eq_u32 s3, 1
    s_cbranch_scc1 L_wshare_ld
    s_cmp_eq_u32 s3, 2
    s_cbranch_scc0 L_share_ld_done
    s_cmp_ge_u32 s7, 96
    s_cbranch_scc1 L_share_ld_done
    s_lshl_b32 s12, s5, 5
    v_lshrrev_b32 v186, 2, v1
    v_add_u32 v186, s12, v186
    s_mul_i32 s13, s4, 1536
    v_lshl_add_u32 v187, v186, 1, s13
    s_lshl_b32 s13, s6, 6
    v_lshl_add_u32 v186, v186, 8, s13
    v_lshl_add_u32 v186, v182, 4, v186
    s_waitcnt lgkmcnt(0)
    global_load_ushort v72, v187, s[18:19]
    global_load_ushort v73, v187, s[18:19] offset:32
    global_load_dwordx4 v[76:79], v186, s[26:27]
    v_add_u32 v186, 4096, v186
    global_load_dwordx4 v[80:83], v186, s[26:27]
    s_branch L_share_ld_done
L_wshare_ld:
    s_bfe_u32 s10, s7, 0x40002
    s_mul_i32 s10, s10, 18432
    s_mul_i32 s11, s6, 576
    s_add_u32 s10, s10, s11
    v_lshl_add_u32 v187, v1, 4, s10
    v_add_u32 v186, 0, v1
    v_mul_u32_u24 v186, 1821, v186
    v_lshrrev_b32 v186, 16, v186
    v_mul_u32_u24 v186, 1728, v186
    v_add_u32 v72, v186, v187
    v_add_u32 v186, 64, v1
    v_mul_u32_u24 v186, 1821, v186
    v_lshrrev_b32 v186, 16, v186
    v_mul_u32_u24 v186, 1728, v186
    v_add_u32 v73, v186, v187
    v_add_u32 v186, 128, v1
    v_mul_u32_u24 v186, 1821, v186
    v_lshrrev_b32 v186, 16, v186
    v_mul_u32_u24 v186, 1728, v186
    v_add_u32 v74, v186, v187
    v_add_u32 v186, 192, v1
    v_mul_u32_u24 v186, 1821, v186
    v_lshrrev_b32 v186, 16, v186
    v_mul_u32_u24 v186, 1728, v186
    v_add_u32 v75, v186, v187
    v_add_u32 v186, 256, v1
    v_mul_u32_u24 v186, 1821, v186
    v_lshrrev_b32 v186, 16, v186
    v_mul_u32_u24 v186, 1728, v186
    v_add_u32 v76, v186, v187
    v_add_u32 v76, 4096, v76
    s_mov_b32 m0, s77
    s_cmp_ge_u32 s7, 64
    s_waitcnt lgkmcnt(0)
    s_cselect_b32 s12, s32, s24
    s_cselect_b32 s13, s33, s25
    global_load_lds_dwordx4 v72, s[12:13] offset:0
    global_load_lds_dwordx4 v73, s[12:13] offset:1024
    global_load_lds_dwordx4 v74, s[12:13] offset:2048
    global_load_lds_dwordx4 v75, s[12:13] offset:3072
    s_add_u32 m0, s77, 4096
    s_mov_b32 exec_hi, 0
    global_load_lds_dwordx4 v76, s[12:13]
    s_mov_b32 exec_hi, -1
    s_add_u32 m0, s77, 17536
L_share_ld_done:
    s_waitcnt lgkmcnt(0)
    s_lshl_b32 s10, s4, 8
    s_load_dword s8, s[38:39], s10
    buffer_load_dwordx4 v176, s[40:43], s52 offen offset:0 nt lds
    buffer_load_dwordx4 v176, s[40:43], s53 offen offset:1088 nt lds
    buffer_load_dwordx4 v176, s[40:43], s54 offen offset:2176 nt lds
    buffer_load_dwordx4 v176, s[40:43], s55 offen offset:3264 nt lds
    s_add_u32 m0, s77, 21904
    s_mov_b32 exec_lo, 0x1
    s_mov_b32 exec_hi, 0x1
    global_load_dword v29, v29, s[14:15]
    s_mov_b64 exec, -1
    s_nop 0
    buffer_load_dwordx4 v176, s[40:43], s56 offen offset:0 nt lds
    buffer_load_dwordx4 v176, s[40:43], s57 offen offset:1088 nt lds
    buffer_load_dwordx4 v176, s[40:43], s58 offen offset:2176 nt lds
    buffer_load_dwordx4 v176, s[40:43], s59 offen offset:3264 nt lds
    s_mov_b32 s50, 0x1000000
    s_mov_b32 s51, 0x20000
    s_mov_b32 s60, 0x07060100
    s_mov_b32 s61, 0x05040302
    s_mov_b32 s64, 0xbfb8aa3b
    s_mov_b32 s65, 0xbfb8aa3b
    s_mov_b32 s78, 0xffff0000
    s_mov_b32 s62, 0x3f803f80
    s_mov_b32 s79, 0
    v_lshlrev_b32 v2, 4, v1
    v_mov_b32 v17, 0
    v_mov_b32 v183, 0x80000000
    s_add_u32 s11, s77, 17536
    v_add_u32 v178, s11, v2
    v_bfe_u32 v186, v1, 3, 2
    v_bfe_u32 v187, v1, 2, 1
    v_mul_u32_u24 v177, 1280, v187
    v_lshl_add_u32 v177, v186, 18, v177
    v_lshl_add_u32 v177, v181, 17, v177
    v_lshl_add_u32 v177, v182, 4, v177
    v_mul_u32_u24 v24, 31, v187
    v_cmp_eq_u32 vcc, s5, v24
    s_sub_u32 s10, s66, 256
    v_add_u32 v177, s10, v177
    v_cndmask_b32 v177, v177, v183, vcc
    v_mul_u32_u24 v20, 1088, v185
    v_and_b32 v24, 1, v184
    v_lshl_add_u32 v20, v24, 5, v20
    v_lshl_add_u32 v20, v182, 3, v20
    v_add_u32 v20, s11, v20
    v_lshl_add_u32 v21, v181, 9, v20
    v_mul_u32_u24 v24, 4368, v181
    v_add_u32 v20, v20, v24
    v_and_b32 v185, 7, v1
    v_mul_u32_u24 v179, 1088, v185
    v_lshl_add_u32 v179, v186, 8, v179
    v_lshl_add_u32 v179, v187, 4, v179
    v_lshl_add_u32 v179, v181, 3, v179
    v_add_u32 v179, s11, v179
    s_lshl_b32 s10, s3, 8
    v_lshl_add_u32 v12, v186, 4, v185
    v_lshl_add_u32 v12, v12, 2, s10
    v_lshl_add_u32 v11, v181, 4, s10
    v_mul_u32_u24 v8, 4384, v186
    v_lshl_add_u32 v8, v185, 1, v8
    v_mul_u32_u24 v24, 528, v181
    v_add3_u32 v8, v8, v24, s77
    s_lshl_b32 s10, s4, 22
    s_lshl_b32 s12, s3, 20
    s_add_u32 s10, s10, s12
    s_lshl_b32 s12, s5, 13
    s_add_u32 s10, s10, s12
    s_lshl_b32 s12, s6, 9
    s_add_u32 s11, s10, s12
    s_add_u32 s10, s77, 17536
    v_lshl_add_u32 v9, v181, 6, s10
    v_lshl_add_u32 v9, v187, 5, v9
    v_lshl_add_u32 v9, v186, 3, v9
    v_lshl_add_u32 v9, v182, 1, v9
    v_mul_u32_u24 v24, 3, v181
    v_cmp_ne_u32 s[14:15], s6, v24
    v_lshlrev_b32 v184, 4, v180
    v_mul_u32_u24 v10, 1536, v181
    v_add_u32 v10, v10, v184
    v_cndmask_b32 v10, v183, v10, s[14:15]
    v_cndmask_b32 v27, 0, 1.0, s[14:15]
    s_lshl_b32 s10, s4, 2
    s_add_u32 s10, s10, s3
    s_mul_i32 s76, s10, 196608
    s_add_u32 s76, s76, 0x100000
    s_lshl_b32 s10, s10, 17
    s_lshl_b32 s12, s7, 10
    s_add_u32 s10, s10, s12
    s_add_u32 s0, s10, 0x2ffe00
    v_lshl_add_u32 v6, v181, 18, v184
    v_add_u32 v6, s11, v6
    v_mul_u32_u24 v3, 30720, v181
    v_add_u32 v3, v3, v184
    v_add_u32 v4, 63744, v3
    v_add_u32 v3, 2304, v3
    v_lshl_add_u32 v7, v181, 3, v184
    v_add3_u32 v7, v7, s77, 16
    v_lshrrev_b32 v24, 2, v1
    v_lshlrev_b32 v5, 15, v24
    v_lshl_add_u32 v5, v182, 4, v5
    v_add_u32 v5, s66, v5
    s_add_u32 s10, s77, 17536
    v_mul_u32_u24 v0, 80, v24
    v_lshl_add_u32 v0, v182, 4, v0
    v_add_u32 v0, s10, v0
    v_mul_u32_u24 v19, 80, v180
    v_lshl_add_u32 v19, v181, 3, v19
    v_add_u32 v19, s10, v19
    v_lshrrev_b32 v18, 3, v1
    v_lshlrev_b32 v18, 9, v18
    v_lshl_add_u32 v18, v185, 4, v18
    v_mul_u32_u24 v184, 54, v181
    v_add_u32 v184, v184, v179
    s_mov_b32 s46, 0x800000
    s_mov_b32 s47, 0x20000
    s_mov_b32 s63, 524288
    s_mov_b32 s68, 0x400000
    s_mov_b32 s69, 0x401000
    s_mov_b32 s70, 0x480000
    s_mov_b32 s71, 0x481000
    s_cmp_lg_u32 s5, 0
    s_mov_b32 s72, 0x40000000
    s_cselect_b32 s72, 0x3ff800, s72
    s_mov_b32 s73, 0x40000000
    s_cselect_b32 s73, 0x47f800, s73
    s_cselect_b32 s16, 1.0, 0
    s_cselect_b32 s17, 1.0, 0
    s_cselect_b32 s26, -1, 0
    s_cselect_b32 s10, s64, 0xff800000
    v_mov_b32 v254, s10
    s_cselect_b32 s24, 0xfffff000, s72
    s_cmp_lg_u32 s5, 31
    s_mov_b32 s74, 0x40000000
    s_cselect_b32 s74, 0x402000, s74
    s_mov_b32 s75, 0x40000000
    s_cselect_b32 s75, 0x482000, s75
    s_cselect_b32 s18, 1.0, 0
    s_cselect_b32 s19, 1.0, 0
    s_cselect_b32 s27, -1, 0
    s_cselect_b32 s10, s64, 0xff800000
    v_mov_b32 v255, s10
    s_cselect_b32 s25, 4096, s74
    s_add_u32 s24, s24, s0
    s_add_u32 s25, s25, s0
    v_mov_b32 v192, 0
    v_mov_b32 v193, 0
    v_mov_b32 v194, 0
    v_mov_b32 v195, 0
    v_mov_b32 v196, 0
    v_mov_b32 v197, 0
    v_mov_b32 v198, 0
    v_mov_b32 v199, 0
    s_cmp_eq_u32 s3, 1
    s_cbranch_scc1 L_wshare
    s_cmp_eq_u32 s3, 2
    s_cbranch_scc0 L_shares_done
    s_cmp_ge_u32 s7, 96
    s_cbranch_scc1 L_shares_done
    s_mul_i32 s12, s4, 12288
    s_lshl_b32 s13, s7, 7
    s_add_u32 s12, s12, s13
    s_add_u32 s12, s12, 0x10000
    v_lshrrev_b32 v186, 4, v1
    v_lshlrev_b32 v186, 3, v186
    v_lshl_add_u32 v186, v182, 5, v186
    s_waitcnt vmcnt(9)
    v_lshlrev_b32 v72, 16, v72
    v_lshlrev_b32 v73, 16, v73
    v_mul_f32 v74, s64, v72
    v_mul_f32 v75, s64, v73
    v_exp_f32 v74, v74
    v_exp_f32 v75, v75
    s_nop 0
    v_add_f32 v74, 1.0, v74
    v_add_f32 v75, 1.0, v75
    v_rcp_f32 v74, v74
    v_rcp_f32 v75, v75
    s_nop 0
    v_mul_f32 v72, v72, v74
    v_mul_f32 v73, v73, v75
    v_cvt_pk_bf16_f32 v74, v72, v73
    v_lshlrev_b32 v72, 16, v74
    v_and_b32 v73, s78, v74
    v_lshlrev_b32 v92, 16, v76
    v_lshlrev_b32 v93, 16, v80
    v_mul_f32 v84, v72, v92
    v_fmac_f32 v84, v73, v93
    v_and_b32 v92, s78, v76
    v_and_b32 v93, s78, v80
    v_mul_f32 v85, v72, v92
    v_fmac_f32 v85, v73, v93
    v_lshlrev_b32 v92, 16, v77
    v_lshlrev_b32 v93, 16, v81
    v_mul_f32 v86, v72, v92
    v_fmac_f32 v86, v73, v93
    v_and_b32 v92, s78, v77
    v_and_b32 v93, s78, v81
    v_mul_f32 v87, v72, v92
    v_fmac_f32 v87, v73, v93
    v_lshlrev_b32 v92, 16, v78
    v_lshlrev_b32 v93, 16, v82
    v_mul_f32 v88, v72, v92
    v_fmac_f32 v88, v73, v93
    v_and_b32 v92, s78, v78
    v_and_b32 v93, s78, v82
    v_mul_f32 v89, v72, v92
    v_fmac_f32 v89, v73, v93
    v_lshlrev_b32 v92, 16, v79
    v_lshlrev_b32 v93, 16, v83
    v_mul_f32 v90, v72, v92
    v_fmac_f32 v90, v73, v93
    v_and_b32 v92, s78, v79
    v_and_b32 v93, s78, v83
    v_mul_f32 v91, v72, v92
    v_fmac_f32 v91, v73, v93
    s_nop 1
    v_permlane32_swap_b32 v84, v88
    v_permlane32_swap_b32 v85, v89
    v_permlane32_swap_b32 v86, v90
    v_permlane32_swap_b32 v87, v91
    v_add_f32 v84, v84, v88
    v_add_f32 v85, v85, v89
    v_add_f32 v86, v86, v90
    v_add_f32 v87, v87, v91
    s_nop 1
    v_permlane16_swap_b32 v84, v86
    v_permlane16_swap_b32 v85, v87
    v_add_f32 v84, v84, v86
    v_add_f32 v85, v85, v87
    s_nop 1
    v_add_f32_dpp v84, v84, v84 row_shr:4 row_mask:0xf bank_mask:0xf bound_ctrl:0
    v_add_f32_dpp v85, v85, v85 row_shr:4 row_mask:0xf bank_mask:0xf bound_ctrl:0
    s_nop 0
    v_add_f32_dpp v84, v84, v84 row_shr:8 row_mask:0xf bank_mask:0xf bound_ctrl:0
    v_add_f32_dpp v85, v85, v85 row_shr:8 row_mask:0xf bank_mask:0xf bound_ctrl:0
    s_nop 0
    s_mov_b32 exec_lo, 0xf000f000
    s_mov_b32 exec_hi, 0xf000f000
    buffer_store_dwordx2 v[84:85], v186, s[48:51], s12 offen sc1
    s_mov_b32 s79, 1
    s_mov_b64 exec, -1
    s_branch L_shares_done
L_wshare:
    s_lshl_b32 s11, s4, 2
    s_bfe_u32 s12, s7, 0x20004
    s_add_u32 s11, s11, s12
    s_mul_i32 s11, s11, 192
    s_lshr_b32 s12, s7, 6
    s_mul_i32 s12, s12, 96
    s_add_u32 s11, s11, s12
    s_lshl_b32 s11, s11, 10
    s_and_b32 s12, s7, 1
    s_lshl_b32 s12, s12, 9
    s_add_u32 s11, s11, s12
    s_bfe_u32 s12, s7, 0x20002
    s_lshl_b32 s12, s12, 7
    s_add_u32 s11, s11, s12
    s_add_u32 s11, s11, 0x100000
    s_bfe_u32 s10, s7, 0x10001
    v_bfe_u32 v140, v1, 3, 2
    v_and_b32 v141, 7, v1
    v_cmp_eq_u32 vcc, 3, v140
    v_mul_u32_u24 v186, 576, v141
    v_mul_u32_u24 v187, 144, v140
    v_cndmask_b32 v142, 4, 1, vcc
    v_cndmask_b32 v143, 1, 6, vcc
    v_add3_u32 v24, v186, v187, s77
    v_mul_u32_u24 v186, 72, v181
    v_add_u32 v24, v24, v186
    v_mul_u32_u24 v186, 24, v140
    v_mad_u32_u24 v186, v142, s10, v186
    v_mad_u32_u24 v186, v143, v181, v186
    v_lshlrev_b32 v186, 10, v186
    v_lshl_add_u32 v186, v141, 4, v186
    v_lshl_add_u32 v187, v143, 11, v186
    v_lshlrev_b32 v142, 11, v142
    s_waitcnt vmcnt(9)
    ds_read2_b64 v[72:75], v24 offset0:0 offset1:1
    ds_read2_b64 v[76:79], v24 offset0:2 offset1:3
    ds_read2_b64 v[80:83], v24 offset0:4 offset1:5
    ds_read2_b64 v[84:87], v24 offset0:6 offset1:7
    ds_read_b64 v[88:89], v24 offset:64
    s_waitcnt lgkmcnt(0)
    v_and_b32 v92, s78, v72
    v_lshlrev_b32 v93, 16, v77
    v_and_b32 v94, s78, v81
    v_lshlrev_b32 v95, 16, v86
    v_lshlrev_b32 v96, 16, v74
    v_and_b32 v97, s78, v78
    v_lshlrev_b32 v98, 16, v83
    v_and_b32 v99, s78, v87
    v_and_b32 v100, s78, v75
    v_lshlrev_b32 v101, 16, v80
    v_and_b32 v102, s78, v84
    v_lshlrev_b32 v103, 16, v89
    v_perm_b32 v112, v77, v72, s61
    v_perm_b32 v114, v80, v75, s61
    v_perm_b32 v113, v86, v81, s61
    v_perm_b32 v115, v89, v84, s61
    v_pk_add_f32 v[92:93], v[92:93], v[100:101]
    v_pk_add_f32 v[94:95], v[94:95], v[102:103]
    v_pk_add_f32 v[100:101], v[92:93], v[96:97]
    v_pk_add_f32 v[102:103], v[94:95], v[98:99]
    v_pk_add_f32 v[92:93], v[92:93], v[96:97] neg_lo:[0,1] neg_hi:[0,1]
    v_pk_add_f32 v[94:95], v[94:95], v[98:99] neg_lo:[0,1] neg_hi:[0,1]
    v_cvt_pk_bf16_f32 v108, v100, v101
    v_cvt_pk_bf16_f32 v109, v102, v103
    v_cvt_pk_bf16_f32 v110, v92, v93
    v_cvt_pk_bf16_f32 v111, v94, v95
    v_permlane32_swap_b32 v112, v114
    v_permlane32_swap_b32 v113, v115
    v_permlane32_swap_b32 v108, v110
    v_permlane32_swap_b32 v109, v111
    buffer_store_dwordx4 v[108:111], v186, s[48:51], s11 offen sc1
    buffer_store_dwordx4 v[112:115], v187, s[48:51], s11 offen sc1
    v_lshlrev_b32 v92, 16, v72
    v_and_b32 v93, s78, v76
    v_lshlrev_b32 v94, 16, v81
    v_and_b32 v95, s78, v85
    v_and_b32 v96, s78, v73
    v_lshlrev_b32 v97, 16, v78
    v_and_b32 v98, s78, v82
    v_lshlrev_b32 v99, 16, v87
    v_lshlrev_b32 v100, 16, v75
    v_and_b32 v101, s78, v79
    v_lshlrev_b32 v102, 16, v84
    v_and_b32 v103, s78, v88
    v_perm_b32 v120, v76, v72, s60
    v_perm_b32 v122, v79, v75, s60
    v_perm_b32 v121, v85, v81, s60
    v_perm_b32 v123, v88, v84, s60
    v_pk_add_f32 v[92:93], v[92:93], v[100:101]
    v_pk_add_f32 v[94:95], v[94:95], v[102:103]
    v_pk_add_f32 v[100:101], v[92:93], v[96:97]
    v_pk_add_f32 v[102:103], v[94:95], v[98:99]
    v_pk_add_f32 v[92:93], v[92:93], v[96:97] neg_lo:[0,1] neg_hi:[0,1]
    v_pk_add_f32 v[94:95], v[94:95], v[98:99] neg_lo:[0,1] neg_hi:[0,1]
    v_cvt_pk_bf16_f32 v116, v100, v101
    v_cvt_pk_bf16_f32 v117, v102, v103
    v_cvt_pk_bf16_f32 v118, v92, v93
    v_cvt_pk_bf16_f32 v119, v94, v95
    v_add_u32 v186, v186, v142
    v_add_u32 v187, v187, v142
    v_permlane32_swap_b32 v120, v122
    v_permlane32_swap_b32 v121, v123
    v_permlane32_swap_b32 v116, v118
    v_permlane32_swap_b32 v117, v119
    buffer_store_dwordx4 v[116:119], v186, s[48:51], s11 offen sc1
    buffer_store_dwordx4 v[120:123], v187, s[48:51], s11 offen sc1
    v_lshlrev_b32 v92, 16, v73
    v_and_b32 v93, s78, v77
    v_lshlrev_b32 v94, 16, v82
    v_and_b32 v95, s78, v86
    v_and_b32 v96, s78, v74
    v_lshlrev_b32 v97, 16, v79
    v_and_b32 v98, s78, v83
    v_lshlrev_b32 v99, 16, v88
    v_lshlrev_b32 v100, 16, v76
    v_and_b32 v101, s78, v80
    v_lshlrev_b32 v102, 16, v85
    v_and_b32 v103, s78, v89
    v_perm_b32 v128, v77, v73, s60
    v_perm_b32 v130, v80, v76, s60
    v_perm_b32 v129, v86, v82, s60
    v_perm_b32 v131, v89, v85, s60
    v_pk_add_f32 v[92:93], v[92:93], v[100:101]
    v_pk_add_f32 v[94:95], v[94:95], v[102:103]
    v_pk_add_f32 v[100:101], v[92:93], v[96:97]
    v_pk_add_f32 v[102:103], v[94:95], v[98:99]
    v_pk_add_f32 v[92:93], v[92:93], v[96:97] neg_lo:[0,1] neg_hi:[0,1]
    v_pk_add_f32 v[94:95], v[94:95], v[98:99] neg_lo:[0,1] neg_hi:[0,1]
    v_cvt_pk_bf16_f32 v124, v100, v101
    v_cvt_pk_bf16_f32 v125, v102, v103
    v_cvt_pk_bf16_f32 v126, v92, v93
    v_cvt_pk_bf16_f32 v127, v94, v95
    v_add_u32 v186, v186, v142
    v_add_u32 v187, v187, v142
    v_permlane32_swap_b32 v128, v130
    v_permlane32_swap_b32 v129, v131
    v_permlane32_swap_b32 v124, v126
    v_permlane32_swap_b32 v125, v127
    buffer_store_dwordx4 v[124:127], v186, s[48:51], s11 offen sc1
    buffer_store_dwordx4 v[128:131], v187, s[48:51], s11 offen sc1
    s_mov_b32 s79, 2
L_shares_done:
    s_mov_b64 exec, 0
    s_cmp_eq_u32 s3, 1
    s_cbranch_scc1 L_hop1
    s_cmp_eq_u32 s3, 2
    s_cbranch_scc1 L_hop2
    s_cmp_eq_u32 s3, 3
    s_cbranch_scc1 L_hop3
    s_branch L_main
.p2align 12
L_main:
L_hop0:
    s_cbranch_execz L_hop4
L_hop_ret:
    s_mov_b64 exec, -1
    s_waitcnt vmcnt(6) lgkmcnt(0)
    s_cmp_eq_u32 s79, 2
    s_cbranch_scc1 L_xin
    s_waitcnt vmcnt(1)
    s_cmp_eq_u32 s79, 1
    s_cbranch_scc1 L_xin
    s_waitcnt vmcnt(0)
L_xin:
    ds_read_b128 v[32:35], v178 offset:0
    ds_read_b128 v[36:39], v178 offset:1088
    ds_read_b128 v[40:43], v178 offset:2176
    ds_read_b128 v[44:47], v178 offset:3264
    ds_read_b128 v[48:51], v178 offset:4368
    ds_read_b128 v[52:55], v178 offset:5456
    ds_read_b128 v[56:59], v178 offset:6544
    ds_read_b128 v[60:63], v178 offset:7632
    ds_read_u16 v64, v184 offset:0
    ds_read_u16 v65, v184 offset:64
    ds_read_u16 v66, v184 offset:128
    ds_read_u16 v67, v184 offset:192
    s_mul_i32 s9, s8, 0x9E3779B1
    s_add_u32 s9, s9, 0x7F4A7C15
    s_add_u32 m0, s77, 26304
    s_waitcnt lgkmcnt(11)
    v_dot2c_f32_bf16 v192, s62, v32
    v_dot2c_f32_bf16 v196, v32, v32
    v_dot2c_f32_bf16 v193, s62, v33
    v_dot2c_f32_bf16 v197, v33, v33
    v_dot2c_f32_bf16 v194, s62, v34
    v_dot2c_f32_bf16 v198, v34, v34
    v_dot2c_f32_bf16 v195, s62, v35
    v_dot2c_f32_bf16 v199, v35, v35
    s_waitcnt lgkmcnt(10)
    v_dot2c_f32_bf16 v192, s62, v36
    v_dot2c_f32_bf16 v196, v36, v36
    v_dot2c_f32_bf16 v193, s62, v37
    v_dot2c_f32_bf16 v197, v37, v37
    v_dot2c_f32_bf16 v194, s62, v38
    v_dot2c_f32_bf16 v198, v38, v38
    v_dot2c_f32_bf16 v195, s62, v39
    v_dot2c_f32_bf16 v199, v39, v39
    s_waitcnt lgkmcnt(9)
    v_dot2c_f32_bf16 v192, s62, v40
    v_dot2c_f32_bf16 v196, v40, v40
    v_dot2c_f32_bf16 v193, s62, v41
    v_dot2c_f32_bf16 v197, v41, v41
    v_dot2c_f32_bf16 v194, s62, v42
    v_dot2c_f32_bf16 v198, v42, v42
    v_dot2c_f32_bf16 v195, s62, v43
    v_dot2c_f32_bf16 v199, v43, v43
    s_waitcnt lgkmcnt(8)
    v_dot2c_f32_bf16 v192, s62, v44
    v_dot2c_f32_bf16 v196, v44, v44
    v_dot2c_f32_bf16 v193, s62, v45
    v_dot2c_f32_bf16 v197, v45, v45
    v_dot2c_f32_bf16 v194, s62, v46
    v_dot2c_f32_bf16 v198, v46, v46
    v_dot2c_f32_bf16 v195, s62, v47
    v_dot2c_f32_bf16 v199, v47, v47
    s_waitcnt lgkmcnt(7)
    v_dot2c_f32_bf16 v192, s62, v48
    v_dot2c_f32_bf16 v196, v48, v48
    v_dot2c_f32_bf16 v193, s62, v49
    v_dot2c_f32_bf16 v197, v49, v49
    v_dot2c_f32_bf16 v194, s62, v50
    v_dot2c_f32_bf16 v198, v50, v50
    v_dot2c_f32_bf16 v195, s62, v51
    v_dot2c_f32_bf16 v199, v51, v51
    s_waitcnt lgkmcnt(6)
    v_dot2c_f32_bf16 v192, s62, v52
    v_dot2c_f32_bf16 v196, v52, v52
    v_dot2c_f32_bf16 v193, s62, v53
    v_dot2c_f32_bf16 v197, v53, v53
    v_dot2c_f32_bf16 v194, s62, v54
    v_dot2c_f32_bf16 v198, v54, v54
    v_dot2c_f32_bf16 v195, s62, v55
    v_dot2c_f32_bf16 v199, v55, v55
    s_waitcnt lgkmcnt(5)
    v_dot2c_f32_bf16 v192, s62, v56
    v_dot2c_f32_bf16 v196, v56, v56
    v_dot2c_f32_bf16 v193, s62, v57
    v_dot2c_f32_bf16 v197, v57, v57
    v_dot2c_f32_bf16 v194, s62, v58
    v_dot2c_f32_bf16 v198, v58, v58
    v_dot2c_f32_bf16 v195, s62, v59
    v_dot2c_f32_bf16 v199, v59, v59
    s_waitcnt lgkmcnt(4)
    v_dot2c_f32_bf16 v192, s62, v60
    v_dot2c_f32_bf16 v196, v60, v60
    v_dot2c_f32_bf16 v193, s62, v61
    v_dot2c_f32_bf16 v197, v61, v61
    v_dot2c_f32_bf16 v194, s62, v62
    v_dot2c_f32_bf16 v198, v62, v62
    v_dot2c_f32_bf16 v195, s62, v63
    v_dot2c_f32_bf16 v199, v63, v63
    v_mov_b32 v69, s9
    v_mov_b32 v71, s9
    s_nop 0
    v_add_f32 v192, v192, v193
    v_add_f32 v194, v194, v195
    v_add_f32 v196, v196, v197
    v_add_f32 v198, v198, v199
    v_add_f32 v22, v192, v194
    v_add_f32 v23, v196, v198
    s_nop 1
    v_add_f32_dpp v22, v22, v22 row_shr:1 row_mask:0xf bank_mask:0xf bound_ctrl:0
    v_add_f32_dpp v23, v23, v23 row_shr:1 row_mask:0xf bank_mask:0xf bound_ctrl:0
    s_nop 0
    v_add_f32_dpp v22, v22, v22 row_shr:2 row_mask:0xf bank_mask:0xf bound_ctrl:0
    v_add_f32_dpp v23, v23, v23 row_shr:2 row_mask:0xf bank_mask:0xf bound_ctrl:0
    s_nop 0
    v_add_f32_dpp v22, v22, v22 row_shr:4 row_mask:0xf bank_mask:0xf bound_ctrl:0
    v_add_f32_dpp v23, v23, v23 row_shr:4 row_mask:0xf bank_mask:0xf bound_ctrl:0
    s_nop 0
    v_add_f32_dpp v22, v22, v22 row_shr:8 row_mask:0xf bank_mask:0xf bound_ctrl:0
    v_add_f32_dpp v23, v23, v23 row_shr:8 row_mask:0xf bank_mask:0xf bound_ctrl:0
    s_nop 0
    v_add_f32_dpp v22, v22, v22 row_bcast:15 row_mask:0xa bank_mask:0xf
    v_add_f32_dpp v23, v23, v23 row_bcast:15 row_mask:0xa bank_mask:0xf
    s_nop 0
    v_add_f32_dpp v22, v22, v22 row_bcast:31 row_mask:0xc bank_mask:0xf
    v_add_f32_dpp v23, v23, v23 row_bcast:31 row_mask:0xc bank_mask:0xf
    s_nop 0
    s_lshl_b32 s10, s3, 3
    v_mov_b32 v24, s10
    s_mov_b32 exec_lo, 0x0
    s_mov_b32 exec_hi, 0x80000000
    ds_write_b64 v24, v[22:23] offset:2048
    s_mov_b64 exec, -1
    s_lshl_b32 s12, s4, 9
    s_add_u32 s13, s12, s7
    s_lshl_b32 s13, s13, 6
    s_add_u32 s13, s13, 0x40000
    v_and_b32 v24, 3, v1
    v_lshrrev_b32 v30, 2, v1
    v_lshlrev_b32_e64 v30, 13, v30
    v_lshl_add_u32 v30, v24, 4, v30
    v_lshlrev_b32 v24, 3, v24
    v_mov_b32 v49, s9
    v_mov_b32_e64 v51, s9
    s_cmp_lg_u32 s3, 0
    s_waitcnt lgkmcnt(0)
    v_lshl_or_b32 v68, v65, 16, v64
    v_lshl_or_b32 v70, v67, 16, v66
    buffer_store_dwordx4 v[68:71], v2, s[48:51], s0 offen offset:512 sc1
    buffer_load_dwordx4 v177, s[40:43], s52 offen offset:0 nt lds
    buffer_load_dwordx4 v177, s[40:43], s53 offen offset:1088 nt lds
    buffer_load_dwordx4 v177, s[40:43], s54 offen offset:2176 nt lds
    buffer_load_dwordx4 v177, s[40:43], s55 offen offset:3264 nt lds
    global_load_ushort v13, v28, s[20:21]
    global_load_ushort v14, v28, s[22:23]
    global_load_ushort v15, v28, s[28:29]
    global_load_ushort v16, v28, s[30:31]
    s_waitcnt vmcnt(9)
    s_barrier
    s_cbranch_scc1 L_pub1_done
    s_mov_b64 exec, 0xffff
    ds_read_b32 v48, v24 offset:2048
    ds_read_b32 v50, v24 offset:2052
    s_waitcnt lgkmcnt(0)
    buffer_store_dwordx4 v[48:51], v30, s[48:51], s13 offen sc1
    s_mov_b64 exec, -1
L_pub1_done:
    s_lshl_b32 s13, s3, 5
    s_add_u32 s12, s12, s13
    s_lshr_b32 s13, s7, 5
    s_lshl_b32 s13, s13, 7
    s_add_u32 s12, s12, s13
    s_lshl_b32 s12, s12, 6
    s_add_u32 s1, s12, 0x40000
    ds_read_b64 a[224:225], v179 offset:0
    ds_read_b64 a[226:227], v179 offset:16
    ds_read_b64 a[228:229], v179 offset:32
    ds_read_b64 a[230:231], v179 offset:48
    ds_read_b64 a[232:233], v179 offset:64
    ds_read_b64 a[234:235], v179 offset:80
    ds_read_b64 a[236:237], v179 offset:96
    ds_read_b64 a[238:239], v179 offset:112
    ds_read_b64 a[240:241], v179 offset:128
    ds_read_b64 a[242:243], v179 offset:144
    ds_read_b64 a[244:245], v179 offset:160
    ds_read_b64 a[246:247], v179 offset:176
    ds_read_b64 a[248:249], v179 offset:192
    ds_read_b64 a[250:251], v179 offset:208
    ds_read_b64 a[252:253], v179 offset:224
    ds_read_b64 a[254:255], v179 offset:240
    s_waitcnt vmcnt(0)
    v_lshlrev_b32 v13, 16, v13
    v_lshlrev_b32 v14, 16, v14
    v_lshlrev_b32 v15, 16, v15
    v_lshlrev_b32 v16, 16, v16
    v_mul_f32 v13, s64, v13
    v_mul_f32 v14, s64, v14
    v_mul_f32 v15, s64, v15
    v_mul_f32_e64 v16, s64, v16
    s_lshl_b32 s10, s3, 6
    v_lshl_add_u32 v24, v1, 2, s10
    v_lshl_add_u32 v28, v181, 4, s10
    s_mov_b64 exec, 0xff
    ds_write_b32 v24, v13 offset:1024
    ds_write_b32 v24, v14 offset:1056
    ds_write_b32 v24, v15 offset:1280
    ds_write_b32 v24, v16 offset:1312
    s_mov_b64 exec, -1
    ds_read_b64_tr_b16 v[226:227], v20 offset:0
    ds_read_b64_tr_b16 v[228:229], v20 offset:64
    ds_read_b64_tr_b16 v[230:231], v20 offset:128
    ds_read_b64_tr_b16 v[232:233], v20 offset:192
    ds_read_b128 v[240:243], v28 offset:1024
    ds_read_b128 v[244:247], v28 offset:1056
    s_waitcnt vmcnt(0)
    buffer_load_dwordx4 v[52:55], v2, s[48:51], s1 offen sc1
    buffer_load_dwordx4 v[56:59], v2, s[48:51], s1 offen offset:1024 sc1
    ds_read_b64_tr_b16 v[224:225], v21 offset:8768
    ds_read_b64_tr_b16 v[234:235], v21 offset:8832
    s_waitcnt lgkmcnt(0)
    v_lshlrev_b32 v192, 16, v224
    v_and_b32 v193, s78, v224
    v_lshlrev_b32 v194, 16, v225
    v_and_b32 v195, s78, v225
    v_lshlrev_b32 v196, 16, v226
    v_and_b32 v197, s78, v226
    v_lshlrev_b32 v198, 16, v227
    v_and_b32 v199, s78, v227
    v_lshlrev_b32 v200, 16, v228
    v_and_b32 v201, s78, v228
    v_lshlrev_b32 v202, 16, v229
    v_and_b32 v203, s78, v229
    v_lshlrev_b32 v204, 16, v230
    v_and_b32 v205, s78, v230
    v_lshlrev_b32 v206, 16, v231
    v_and_b32 v207, s78, v231
    v_lshlrev_b32 v208, 16, v232
    v_and_b32 v209, s78, v232
    v_lshlrev_b32 v210, 16, v233
    v_and_b32 v211, s78, v233
    v_lshlrev_b32 v212, 16, v234
    v_and_b32 v213, s78, v234
    v_lshlrev_b32 v214, 16, v235
    v_and_b32 v215, s78, v235
    s_mov_b32 s67, 0
    s_waitcnt vmcnt(0)
L_poll1:
    v_xor_b32 v60, s9, v53
    v_xor_b32 v61, s9, v55
    v_xor_b32 v62, s9, v57
    v_xor_b32 v63, s9, v59
    v_or3_b32 v60, v60, v61, v62
    v_or_b32_e64 v60, v60, v63
    v_cmp_ne_u32 vcc, 0, v60
    s_cbranch_vccz L_poll1_done
    s_add_u32 s67, s67, 1
    s_cmp_ge_u32 s67, 200000
    s_cbranch_scc1 L_poll1_done
    s_sleep 1
    buffer_load_dwordx4 v[52:55], v2, s[48:51], s1 offen sc1
    buffer_load_dwordx4 v[56:59], v2, s[48:51], s1 offen offset:1024 sc1
    s_waitcnt vmcnt(0)
    s_branch L_poll1
L_poll1_done:
    v_add_f32 v52, v52, v56
    v_add_f32 v54, v54, v58
    v_and_b32 v53, 3, v1
    v_lshrrev_b32 v55, 5, v1
    v_permlane32_swap_b32 v52, v54
    v_lshlrev_b32 v53, 5, v53
    v_add_f32 v52, v52, v54
    v_lshl_add_u32 v53, v55, 4, v53
    v_mov_b32 v54, v52
    s_lshl_b32 s10, s3, 2
    v_add_u32 v53, s10, v53
    v_permlane16_swap_b32 v52, v54
    s_lshl_b32 s10, s3, 5
    v_add_f32 v52, v52, v54
    v_mov_b32 v24, s10
    s_nop 0
    v_add_f32_dpp v52, v52, v52 row_shr:4 row_mask:0xf bank_mask:0xf bound_ctrl:0
    s_nop 1
    v_add_f32_dpp v52, v52, v52 row_shr:8 row_mask:0xf bank_mask:0xf bound_ctrl:0
    s_mov_b32 exec_lo, 0xf000
    s_mov_b32 exec_hi, 0xf000
    ds_write_b32 v53, v52 offset:2112
    s_mov_b64 exec, -1
    s_waitcnt lgkmcnt(0)
    s_barrier
    ds_read_b128 v[52:55], v24 offset:2112
    ds_read_b128 v[56:59], v24 offset:2128
    buffer_load_dwordx4 a[0:3], v2, s[48:51], s76 offen offset:0 sc1
    buffer_load_dwordx4 a[4:7], v2, s[48:51], s76 offen offset:1024 sc1
    s_waitcnt lgkmcnt(0)
    v_pk_add_f32 v[52:53], v[52:53], v[54:55]
    v_pk_add_f32 v[56:57], v[56:57], v[58:59]
    v_add_f32_e64 v22, v52, v53
    v_add_f32 v30, v56, v57
    v_mul_f32 v22, 0xb6000000, v22
    v_mul_f32 v30, 0x36000000, v30
    v_fma_f32 v30, -v22, v22, v30
    v_max_f32 v30, 0, v30
    v_add_f32 v30, 0x3727c5ac, v30
    v_rsq_f32 v30, v30
    buffer_load_dwordx4 v[128:131], v10, s[48:51], s0 offen sc1
    v_mov_b32 v23, v22
    v_mov_b32_e64 v31, v30
    v_pk_mul_f32 v[240:241], v[240:241], v[30:31]
    v_pk_mul_f32 v[242:243], v[242:243], v[30:31]
    v_pk_fma_f32 v[244:245], v[240:241], v[22:23], v[244:245]
    v_pk_fma_f32 v[246:247], v[242:243], v[22:23], v[246:247]
    v_pk_fma_f32 v[200:201], v[200:201], v[240:241], v[244:245]
    v_pk_fma_f32 v[202:203], v[202:203], v[242:243], v[246:247]
    v_pk_fma_f32 v[204:205], v[204:205], v[240:241], v[244:245]
    v_pk_fma_f32 v[206:207], v[206:207], v[242:243], v[246:247]
    v_exp_f32 v216, v200
    v_exp_f32 v217, v201
    v_exp_f32 v218, v202
    v_exp_f32 v219, v203
    v_exp_f32 v220, v204
    v_exp_f32 v221, v205
    v_exp_f32 v222, v206
    v_exp_f32 v223, v207
    buffer_load_dwordx2 v[132:133], v10, s[48:51], s24 offen offset:8 sc1
    v_mul_f32_e64 v25, v30, v13
    v_fma_f32 v26, v22, v25, v14
    v_pk_fma_f32 v[216:217], v[216:217], s[64:65], s[64:65]
    v_pk_fma_f32 v[218:219], v[218:219], s[64:65], s[64:65]
    v_pk_fma_f32 v[220:221], v[220:221], s[64:65], s[64:65]
    v_pk_fma_f32 v[222:223], v[222:223], s[64:65], s[64:65]
    v_rcp_f32 v216, v216
    v_rcp_f32 v217, v217
    v_rcp_f32 v218, v218
    v_rcp_f32 v219, v219
    v_rcp_f32 v220, v220
    v_rcp_f32 v221, v221
    v_rcp_f32 v222, v222
    v_rcp_f32 v223, v223
    buffer_load_dwordx2 v[134:135], v10, s[48:51], s25 offen sc1
    ds_write2_b32 v12, v25, v26 offset0:0 offset1:8
    v_pk_mul_f32 v[200:201], v[200:201], v[216:217]
    v_pk_mul_f32 v[202:203], v[202:203], v[218:219]
    v_pk_mul_f32 v[204:205], v[204:205], v[220:221]
    v_pk_mul_f32 v[206:207], v[206:207], v[222:223]
    v_pk_fma_f32 v[196:197], v[196:197], v[240:241], v[244:245]
    v_pk_fma_f32 v[198:199], v[198:199], v[242:243], v[246:247]
    v_pk_fma_f32 v[208:209], v[208:209], v[240:241], v[244:245]
    v_pk_fma_f32 v[210:211], v[210:211], v[242:243], v[246:247]
    v_exp_f32 v216, v196
    v_exp_f32 v217, v197
    v_exp_f32 v218, v198
    v_exp_f32 v219, v199
    v_exp_f32 v220, v208
    v_exp_f32 v221, v209
    v_exp_f32 v222, v210
    v_exp_f32 v223, v211
    buffer_load_dwordx4 a[8:11], v2, s[48:51], s76 offen offset:2048 sc1
    v_pk_fma_f32 v[216:217], v[216:217], s[64:65], s[64:65]
    v_pk_fma_f32 v[218:219], v[218:219], s[64:65], s[64:65]
    v_pk_fma_f32 v[220:221], v[220:221], s[64:65], s[64:65]
    v_pk_fma_f32 v[222:223], v[222:223], s[64:65], s[64:65]
    v_rcp_f32 v216, v216
    v_rcp_f32 v217, v217
    v_rcp_f32 v218, v218
    v_rcp_f32 v219, v219
    v_rcp_f32 v220, v220
    v_rcp_f32 v221, v221
    v_rcp_f32 v222, v222
    v_rcp_f32 v223, v223
    buffer_load_dwordx4 a[12:15], v2, s[48:51], s76 offen offset:3072 sc1
    v_pk_fma_f32 v[64:65], v[196:197], v[216:217], v[200:201] neg_lo:[0,0,0] neg_hi:[0,0,0]
    v_pk_fma_f32 v[66:67], v[198:199], v[218:219], v[202:203] neg_lo:[0,0,0] neg_hi:[0,0,0]
    v_cvt_pk_bf16_f32 v64, v64, v65
    v_cvt_pk_bf16_f32 v65, v66, v67
    v_pk_fma_f32 v[68:69], v[196:197], v[216:217], v[200:201] neg_lo:[1,0,0] neg_hi:[1,0,0]
    v_pk_fma_f32 v[70:71], v[198:199], v[218:219], v[202:203] neg_lo:[1,0,0] neg_hi:[1,0,0]
    v_cvt_pk_bf16_f32 v68, v68, v69
    v_cvt_pk_bf16_f32 v69, v70, v71
    ds_write_b64 v7, v[64:65] offset:544
    ds_write_b64 v7, v[68:69] offset:1088
    s_add_u32 s76, s76, 4096
    buffer_load_dwordx4 a[16:19], v2, s[48:51], s76 offen offset:0 sc1
    v_pk_fma_f32 v[72:73], v[196:197], v[216:217], v[204:205] neg_lo:[1,0,0] neg_hi:[1,0,0]
    v_pk_fma_f32 v[74:75], v[198:199], v[218:219], v[206:207] neg_lo:[1,0,0] neg_hi:[1,0,0]
    v_cvt_pk_bf16_f32 v72, v72, v73
    v_cvt_pk_bf16_f32 v73, v74, v75
    v_pk_fma_f32 v[76:77], v[208:209], v[220:221], v[200:201] neg_lo:[1,0,0] neg_hi:[1,0,0]
    v_pk_fma_f32 v[78:79], v[210:211], v[222:223], v[202:203] neg_lo:[1,0,0] neg_hi:[1,0,0]
    v_cvt_pk_bf16_f32 v76, v76, v77
    v_cvt_pk_bf16_f32 v77, v78, v79
    ds_write_b64 v7, v[72:73] offset:1632
    ds_write_b64 v7, v[76:77] offset:2176
    buffer_load_dwordx4 a[20:23], v2, s[48:51], s76 offen offset:1024 sc1
    v_pk_fma_f32 v[112:113], v[208:209], v[220:221], v[204:205] neg_lo:[0,0,0] neg_hi:[0,0,0]
    v_pk_fma_f32 v[114:115], v[210:211], v[222:223], v[206:207] neg_lo:[0,0,0] neg_hi:[0,0,0]
    v_cvt_pk_bf16_f32 v112, v112, v113
    v_cvt_pk_bf16_f32 v113, v114, v115
    v_pk_fma_f32 v[116:117], v[208:209], v[220:221], v[204:205] neg_lo:[0,0,1] neg_hi:[0,0,1]
    v_pk_fma_f32 v[118:119], v[210:211], v[222:223], v[206:207] neg_lo:[0,0,1] neg_hi:[0,0,1]
    v_cvt_pk_bf16_f32 v116, v116, v117
    v_cvt_pk_bf16_f32 v117, v118, v119
    ds_write_b64 v7, v[112:113] offset:2720
    ds_write_b64 v7, v[116:117] offset:3264
    buffer_load_dwordx4 a[24:27], v2, s[48:51], s76 offen offset:2048 sc1
    v_pk_fma_f32 v[192:193], v[192:193], v[240:241], v[244:245]
    v_pk_fma_f32 v[194:195], v[194:195], v[242:243], v[246:247]
    v_pk_fma_f32 v[212:213], v[212:213], v[240:241], v[244:245]
    v_pk_fma_f32 v[214:215], v[214:215], v[242:243], v[246:247]
    v_exp_f32 v216, v192
    v_exp_f32 v217, v193
    v_exp_f32 v218, v194
    v_exp_f32 v219, v195
    v_exp_f32 v220, v212
    v_exp_f32 v221, v213
    v_exp_f32 v222, v214
    v_exp_f32 v223, v215
    buffer_load_dwordx4 a[28:31], v2, s[48:51], s76 offen offset:3072 sc1
    v_pk_fma_f32 v[216:217], v[216:217], s[64:65], v[254:255] op_sel:[0,0,0] op_sel_hi:[1,1,0]
    v_pk_fma_f32 v[218:219], v[218:219], s[64:65], v[254:255] op_sel:[0,0,0] op_sel_hi:[1,1,0]
    v_pk_fma_f32 v[220:221], v[220:221], s[64:65], v[254:255] op_sel:[0,0,1] op_sel_hi:[1,1,1]
    v_pk_fma_f32 v[222:223], v[222:223], s[64:65], v[254:255] op_sel:[0,0,1] op_sel_hi:[1,1,1]
    v_rcp_f32 v216, v216
    v_rcp_f32 v217, v217
    v_rcp_f32 v218, v218
    v_rcp_f32 v219, v219
    v_rcp_f32 v220, v220
    v_rcp_f32 v221, v221
    v_rcp_f32 v222, v222
    v_rcp_f32 v223, v223
    v_pk_fma_f32 v[120:121], v[192:193], v[216:217], v[200:201] neg_lo:[0,0,1] neg_hi:[0,0,1]
    v_pk_fma_f32 v[122:123], v[194:195], v[218:219], v[202:203] neg_lo:[0,0,1] neg_hi:[0,0,1]
    v_cvt_pk_bf16_f32 v120, v120, v121
    v_cvt_pk_bf16_f32 v121, v122, v123
    v_pk_fma_f32 v[124:125], v[212:213], v[220:221], v[204:205] neg_lo:[0,0,1] neg_hi:[0,0,1]
    v_pk_fma_f32 v[126:127], v[214:215], v[222:223], v[206:207] neg_lo:[0,0,1] neg_hi:[0,0,1]
    v_cvt_pk_bf16_f32 v124, v124, v125
    v_cvt_pk_bf16_f32 v125, v126, v127
    ds_write_b64 v7, v[120:121] offset:0
    ds_write_b64 v7, v[124:125] offset:3808
    v_mul_f32 v25, v25, v27
    v_mul_f32 v26, v26, v27
    v_mov_b32 v22, 0
    v_mov_b32 v23, 0
    s_mov_b32 s67, 0
    s_waitcnt vmcnt(6)
L_xc1:
    v_xor_b32 v60, s9, v129
    v_xor_b32 v61, s9, v131
    v_xor_b32 v62, s9, v133
    v_xor_b32 v63, s9, v135
    v_and_b32 v62, s26, v62
    v_and_b32 v63, s27, v63
    v_or3_b32 v60, v60, v61, v62
    v_or_b32 v60, v60, v63
    v_cmp_ne_u32 vcc, 0, v60
    s_and_b64 vcc, vcc, s[14:15]
    s_cbranch_vccnz L_xc1_retry
L_xc1_done:
    s_waitcnt lgkmcnt(0)
    s_barrier
    ds_read_b128 a[192:195], v3 offset:560
    ds_read_b128 a[196:199], v3 offset:2736
    ds_read_b128 a[200:203], v3 offset:1104
    ds_read_b128 a[204:207], v3 offset:3280
    ds_read_b128 a[208:211], v3 offset:16
    v_and_b32 v192, s78, v132
    v_lshlrev_b32 v193, 16, v128
    v_and_b32 v194, s78, v128
    v_lshlrev_b32 v195, 16, v130
    v_and_b32 v196, s78, v130
    v_lshlrev_b32 v197, 16, v134
    v_fma_f32 v192, v192, v25, v26
    v_fma_f32 v193, v193, v25, v26
    v_fma_f32 v194, v194, v25, v26
    v_fma_f32 v195, v195, v25, v26
    v_fma_f32 v196, v196, v25, v26
    v_fma_f32 v197, v197, v25, v26
    v_exp_f32 v216, v192
    v_exp_f32 v217, v193
    v_exp_f32 v218, v194
    v_exp_f32 v219, v195
    v_exp_f32_e64 v220, v196
    v_exp_f32_e64 v221, v197
    s_waitcnt lgkmcnt(4)
    v_mfma_f32_32x32x16_bf16 v[48:63], a[0:3], a[192:195], 0
    s_waitcnt lgkmcnt(3)
    ds_read_b128 a[212:215], v3 offset:2192
    s_add_u32 s76, s76, 4096
    buffer_load_dwordx4 a[32:35], v2, s[48:51], s76 offen offset:0 sc1
    ds_read_b128 v[240:243], v11 offset:64
    ds_read_b128 v[244:247], v11 offset:96
    ds_read_b64_tr_b16 v[228:229], v20 offset:320
    ds_read_b64_tr_b16 v[230:231], v20 offset:384
    ds_read_b64_tr_b16 v[226:227], v20 offset:256
    ds_read_b64_tr_b16 v[232:233], v20 offset:448
    v_mfma_f32_32x32x16_bf16 v[112:127], a[0:3], a[196:199], 0
    s_waitcnt lgkmcnt(9)
    ds_read_b128 a[216:219], v3 offset:1648
    ds_read_b64_tr_b16 v[224:225], v21 offset:8896
    ds_read_b64_tr_b16 v[234:235], v21 offset:8960
    v_fma_f32 v216, v216, s64, v254
    v_fma_f32 v217, v217, s64, s64
    v_fma_f32 v218, v218, s64, s64
    v_fma_f32 v219, v219, s64, s64
    v_fma_f32 v220, v220, s64, s64
    v_fma_f32 v221, v221, s64, v255
    v_mfma_f32_32x32x16_bf16 v[64:79], a[4:7], a[200:203], 0
    s_waitcnt lgkmcnt(11)
    ds_read_b128 a[220:223], v3 offset:3824
    buffer_load_dwordx4 a[36:39], v2, s[48:51], s76 offen offset:1024 sc1
    v_rcp_f32 v216, v216
    v_rcp_f32 v217, v217
    v_rcp_f32 v218, v218
    v_mfma_f32_32x32x16_bf16 v[128:143], a[4:7], a[204:207], 0
    s_waitcnt vmcnt(7) lgkmcnt(11)
    ds_read_b128 a[192:195], v4 offset:560
    v_rcp_f32 v219, v219
    v_rcp_f32 v220, v220
    v_rcp_f32 v221, v221
    v_mul_f32 v194, v194, v218
    v_mul_f32_e64 v195, v195, v219
    v_fma_f32 v200, v192, v216, -v194
    v_mfma_f32_32x32x16_bf16 v[32:47], a[8:11], a[208:211], 0
    s_waitcnt lgkmcnt(11)
    ds_read_b128 a[196:199], v4 offset:2736
    buffer_load_dwordx4 a[40:43], v2, s[48:51], s76 offen offset:2048 sc1
    v_fma_f32 v201, v193, v217, v194
    v_fma_f32 v202, -v193, v217, v194
    v_fma_f32 v203, -v193, v217, v195
    v_fma_f32 v204, -v196, v220, v194
    v_fma_f32 v205, v196, v220, v195
    v_fma_f32 v206, v196, v220, -v195
    v_fma_f32 v207, v197, v221, -v195
    v_mfma_f32_32x32x16_bf16 v[96:111], a[8:11], a[212:215], 0
    s_waitcnt vmcnt(7) lgkmcnt(5)
    ds_read_b128 a[200:203], v4 offset:1104
    buffer_load_dwordx4 a[44:47], v2, s[48:51], s76 offen offset:3072 sc1
    v_cvt_pk_bf16_f32 v212, v200, v201
    v_cvt_pk_bf16_f32 v213, v202, v203
    v_cvt_pk_bf16_f32 v214, v204, v205
    v_cvt_pk_bf16_f32 v215, v206, v207
    v_mfma_f32_32x32x16_bf16 v[80:95], a[12:15], a[216:219], 0
    s_waitcnt lgkmcnt(3)
    ds_read_b128 a[204:207], v4 offset:3280
    ds_write_b16 v8, v212 offset:0
    ds_write_b16_d16_hi v8, v212 offset:544
    ds_write_b16 v8, v213 offset:1088
    ds_write_b16_d16_hi v8, v213 offset:1632
    v_mfma_f32_32x32x16_bf16 v[144:159], a[12:15], a[220:223], 0
    s_waitcnt vmcnt(7) lgkmcnt(7)
    ds_read_b128 a[208:211], v4 offset:16
    s_add_u32 s76, s76, 4096
    buffer_load_dwordx4 a[48:51], v2, s[48:51], s76 offen offset:0 sc1
    ds_write_b16 v8, v214 offset:2176
    ds_write_b16_d16_hi v8, v214 offset:2720
    ds_write_b16 v8, v215 offset:3264
    v_mfma_f32_32x32x16_bf16 v[48:63], a[16:19], a[192:195], v[48:63]
    s_waitcnt lgkmcnt(10)
    ds_read_b128 a[212:215], v4 offset:2192
    buffer_load_dwordx4 a[52:55], v2, s[48:51], s76 offen offset:1024 sc1
    ds_write_b16_d16_hi v8, v215 offset:3808
    v_mfma_f32_32x32x16_bf16 v[112:127], a[16:19], a[196:199], v[112:127]
    s_waitcnt vmcnt(8) lgkmcnt(11)
    ds_read_b128 a[216:219], v4 offset:1648
    v_lshlrev_b32 v200, 16, v228
    v_and_b32 v201, s78, v228
    v_fma_f32 v200, v200, v240, v244
    v_lshlrev_b32 v202, 16, v229
    v_fma_f32 v201, v201, v241, v245
    v_exp_f32 v216, v200
    v_and_b32 v203, s78, v229
    v_fma_f32 v202, v202, v242, v246
    v_mfma_f32_32x32x16_bf16 v[64:79], a[20:23], a[200:203], v[64:79]
    s_waitcnt lgkmcnt(11)
    ds_read_b128 a[220:223], v4 offset:3824
    buffer_load_dwordx4 a[56:59], v2, s[48:51], s76 offen offset:2048 sc1
    v_exp_f32 v217, v201
    v_lshlrev_b32 v204, 16, v230
    v_fma_f32 v203, v203, v243, v247
    v_exp_f32_e64 v218, v202
    v_fma_f32 v216, v216, s64, s64
    v_and_b32_e64 v205, s78, v230
    v_mfma_f32_32x32x16_bf16 v[128:143], a[20:23], a[204:207], v[128:143]
    s_waitcnt vmcnt(8) lgkmcnt(2)
    s_barrier
    ds_read_b128 a[192:195], v3 offset:544
    v_fma_f32 v204, v204, v240, v244
    v_exp_f32 v219, v203
    v_fma_f32 v217, v217, s64, s64
    v_rcp_f32 v216, v216
    v_lshlrev_b32_e64 v206, 16, v231
    v_fma_f32 v205, v205, v241, v245
    v_mfma_f32_32x32x16_bf16 v[32:47], a[24:27], a[208:211], v[32:47]
    ds_read_b128 a[196:199], v3 offset:2720
    buffer_load_dwordx4 a[60:63], v2, s[48:51], s76 offen offset:3072 sc1
    v_exp_f32 v220, v204
    v_fma_f32 v218, v218, s64, s64
    v_rcp_f32 v217, v217
    v_and_b32_e64 v207, s78, v231
    v_fma_f32 v206, v206, v242, v246
    v_mfma_f32_32x32x16_bf16 v[96:111], a[24:27], a[212:215], v[96:111]
    s_waitcnt vmcnt(8) lgkmcnt(3)
    ds_read_b128 a[200:203], v3 offset:1088
    s_add_u32 s76, s76, 4096
    buffer_load_dwordx4 a[64:67], v2, s[48:51], s76 offen offset:0 sc1
    v_exp_f32 v221, v205
    v_fma_f32 v219, v219, s64, s64
    v_mul_f32 v200, v200, v216
    v_rcp_f32 v218, v218
    v_lshlrev_b32 v196, 16, v226
    v_mfma_f32_32x32x16_bf16 v[80:95], a[28:31], a[216:219], v[80:95]
    s_waitcnt lgkmcnt(3)
    ds_read_b128 a[204:207], v3 offset:3264
    v_fma_f32 v207, v207, v243, v247
    v_exp_f32 v222, v206
    v_fma_f32 v220, v220, s64, s64
    v_mul_f32 v201, v201, v217
    v_rcp_f32 v219, v219
    v_and_b32 v197, s78, v226
    v_fma_f32 v196, v196, v240, v244
    v_mfma_f32_32x32x16_bf16 v[144:159], a[28:31], a[220:223], v[144:159]
    s_waitcnt vmcnt(8) lgkmcnt(3)
    ds_read_b128 a[208:211], v3 offset:0
    buffer_load_dwordx4 a[68:71], v2, s[48:51], s76 offen offset:1024 sc1
    v_exp_f32 v223, v207
    v_fma_f32 v221, v221, s64, s64
    v_mul_f32 v202, v202, v218
    v_rcp_f32 v220, v220
    v_lshlrev_b32_e64 v198, 16, v227
    v_fma_f32 v197, v197, v241, v245
    v_mfma_f32_32x32x16_bf16 v[48:63], a[32:35], a[192:195], v[48:63]
    s_waitcnt lgkmcnt(3)
    ds_read_b128 a[212:215], v3 offset:2176
    buffer_load_dwordx4 a[72:75], v2, s[48:51], s76 offen offset:2048 sc1
    v_exp_f32 v216, v196
    v_fma_f32 v222, v222, s64, s64
    v_mul_f32 v203, v203, v219
    v_rcp_f32 v221, v221
    v_and_b32_e64 v199, s78, v227
    v_fma_f32 v198, v198, v242, v246
    v_mfma_f32_32x32x16_bf16 v[112:127], a[32:35], a[196:199], v[112:127]
    s_waitcnt vmcnt(9) lgkmcnt(3)
    ds_read_b128 a[216:219], v3 offset:1632
    buffer_load_dwordx4 a[76:79], v2, s[48:51], s76 offen offset:3072 sc1
    v_exp_f32 v217, v197
    v_fma_f32 v223, v223, s64, s64
    v_mul_f32 v204, v204, v220
    v_rcp_f32 v222, v222
    v_lshlrev_b32_e64 v208, 16, v232
    v_fma_f32 v199, v199, v243, v247
    v_mfma_f32_32x32x16_bf16 v[64:79], a[36:39], a[200:203], v[64:79]
    s_waitcnt lgkmcnt(3)
    ds_read_b128 a[220:223], v3 offset:3808
    v_exp_f32 v218, v198
    v_fma_f32 v216, v216, s64, s64
    v_mul_f32 v205, v205, v221
    v_rcp_f32 v223, v223
    v_and_b32 v209, s78, v232
    v_fma_f32 v208, v208, v240, v244
    v_exp_f32 v219, v199
    v_mfma_f32_32x32x16_bf16 v[128:143], a[36:39], a[204:207], v[128:143]
    s_waitcnt vmcnt(9) lgkmcnt(3)
    ds_read_b128 a[192:195], v4 offset:544
    s_add_u32 s76, s76, 4096
    buffer_load_dwordx4 a[80:83], v2, s[48:51], s76 offen offset:0 sc1
    v_fma_f32 v217, v217, s64, s64
    v_mul_f32 v206, v206, v222
    v_rcp_f32 v216, v216
    v_lshlrev_b32 v210, 16, v233
    v_fma_f32 v209, v209, v241, v245
    v_mfma_f32_32x32x16_bf16 v[32:47], a[40:43], a[208:211], v[32:47]
    s_waitcnt lgkmcnt(3)
    ds_read_b128 a[196:199], v4 offset:2720
    buffer_load_dwordx4 a[84:87], v2, s[48:51], s76 offen offset:1024 sc1
    v_exp_f32 v220, v208
    v_fma_f32 v218, v218, s64, s64
    v_mul_f32 v207, v207, v223
    v_rcp_f32 v217, v217
    v_and_b32 v211, s78, v233
    v_fma_f32 v210, v210, v242, v246
    v_mfma_f32_32x32x16_bf16 v[96:111], a[40:43], a[212:215], v[96:111]
    s_waitcnt vmcnt(10) lgkmcnt(3)
    ds_read_b128 a[200:203], v4 offset:1088
    v_exp_f32_e64 v221, v209
    v_fma_f32 v219, v219, s64, s64
    v_fma_f32 v248, v196, v216, v200
    v_fma_f32 v250, -v196, v216, v200
    v_rcp_f32 v218, v218
    v_fma_f32 v252, -v196, v216, v204
    v_lshlrev_b32 v192, 16, v224
    v_fma_f32 v211, v211, v243, v247
    v_mfma_f32_32x32x16_bf16 v[80:95], a[44:47], a[216:219], v[80:95]
L_hop1:
    s_cbranch_execz L_hop5
    s_waitcnt lgkmcnt(3)
    ds_read_b128 a[204:207], v4 offset:3264
    buffer_load_dwordx4 a[88:91], v2, s[48:51], s76 offen offset:2048 sc1
    v_exp_f32_e64 v222, v210
    v_fma_f32 v220, v220, s64, s64
    v_fma_f32 v249, v197, v217, v201
    v_fma_f32 v251, -v197, v217, v201
    v_rcp_f32 v219, v219
    v_fma_f32 v253, -v197, v217, v205
    v_mfma_f32_32x32x16_bf16 v[144:159], a[44:47], a[220:223], v[144:159]
    s_waitcnt vmcnt(10) lgkmcnt(3)
    ds_read_b128 a[208:211], v4 offset:0
    buffer_load_dwordx4 a[92:95], v2, s[48:51], s76 offen offset:3072 sc1
    v_cvt_pk_bf16_f32 v248, v248, v249
    v_cvt_pk_bf16_f32 v250, v250, v251
    v_cvt_pk_bf16_f32 v252, v252, v253
    v_and_b32 v193, s78, v224
    v_fma_f32 v192, v192, v240, v244
    v_exp_f32 v223, v211
    v_fma_f32 v221, v221, s64, s64
    v_mfma_f32_32x32x16_bf16 v[48:63], a[48:51], a[192:195], v[48:63]
    s_waitcnt lgkmcnt(3)
    ds_read_b128 a[212:215], v4 offset:2176
    s_add_u32 s76, s76, 4096
    buffer_load_dwordx4 a[96:99], v2, s[48:51], s76 offen offset:0 sc1
    v_fma_f32 v249, v198, v218, v202
    v_fma_f32 v251, -v198, v218, v202
    v_rcp_f32 v220, v220
    v_fma_f32 v253, -v198, v218, v206
    v_lshlrev_b32_e64 v194, 16, v225
    v_fma_f32 v193, v193, v241, v245
    v_mfma_f32_32x32x16_bf16 v[112:127], a[48:51], a[196:199], v[112:127]
    s_waitcnt vmcnt(11) lgkmcnt(3)
    ds_read_b128 a[216:219], v4 offset:1632
    v_exp_f32 v216, v192
    v_fma_f32 v222, v222, s64, s64
    v_fma_f32 v30, v199, v219, v203
    v_fma_f32 v31, -v199, v219, v203
    v_rcp_f32_e64 v221, v221
    v_fma_f32 v29, -v199, v219, v207
    v_cvt_pk_bf16_f32 v249, v249, v30
    v_cvt_pk_bf16_f32 v251, v251, v31
    v_mfma_f32_32x32x16_bf16 v[64:79], a[52:55], a[200:203], v[64:79]
    s_waitcnt lgkmcnt(3)
    ds_read_b128 a[220:223], v4 offset:3808
    buffer_load_dwordx4 a[100:103], v2, s[48:51], s76 offen offset:1024 sc1
    ds_write_b64 v7, v[248:249] offset:4928
    ds_write_b64 v7, v[250:251] offset:5472
    v_cvt_pk_bf16_f32 v253, v253, v29
    v_mfma_f32_32x32x16_bf16 v[128:143], a[52:55], a[204:207], v[128:143]
    s_waitcnt vmcnt(11) lgkmcnt(5)
    ds_read_b128 a[192:195], v3 offset:576
    buffer_load_dwordx4 a[104:107], v2, s[48:51], s76 offen offset:2048 sc1
    ds_write_b64 v7, v[252:253] offset:6016
    v_and_b32_e64 v195, s78, v225
    v_fma_f32 v194, v194, v242, v246
    v_exp_f32 v217, v193
    v_fma_f32 v223, v223, s64, s64
    v_mfma_f32_32x32x16_bf16 v[32:47], a[56:59], a[208:211], v[32:47]
    s_waitcnt lgkmcnt(6)
    ds_read_b128 a[196:199], v3 offset:2752
    v_fma_f32 v228, -v208, v220, v200
    v_fma_f32 v230, v208, v220, v204
    v_rcp_f32 v222, v222
    v_fma_f32 v226, v208, v220, -v204
    v_lshlrev_b32 v212, 16, v234
    v_fma_f32 v195, v195, v243, v247
    v_exp_f32 v218, v194
    v_fma_f32 v216, v216, s64, v254
    v_mfma_f32_32x32x16_bf16 v[96:111], a[56:59], a[212:215], v[96:111]
    s_waitcnt vmcnt(11) lgkmcnt(6)
    ds_read_b128 a[200:203], v3 offset:1120
    buffer_load_dwordx4 a[108:111], v2, s[48:51], s76 offen offset:3072 sc1
    v_fma_f32 v229, -v209, v221, v201
    v_fma_f32 v231, v209, v221, v205
    v_rcp_f32_e64 v223, v223
    v_fma_f32 v227, v209, v221, -v205
    v_cvt_pk_bf16_f32 v228, v228, v229
    v_cvt_pk_bf16_f32 v230, v230, v231
    v_cvt_pk_bf16_f32 v226, v226, v227
    v_mfma_f32_32x32x16_bf16 v[80:95], a[60:63], a[216:219], v[80:95]
    s_waitcnt lgkmcnt(6)
    ds_read_b128 a[204:207], v3 offset:3296
    s_add_u32 s76, s76, 4096
    buffer_load_dwordx4 a[112:115], v2, s[48:51], s76 offen offset:0 sc1
    v_and_b32 v213, s78, v234
    v_fma_f32 v212, v212, v240, v244
    v_exp_f32_e64 v219, v195
    v_fma_f32 v217, v217, s64, v254
    v_fma_f32 v229, -v210, v222, v202
    v_fma_f32 v231, v210, v222, v206
    v_mfma_f32_32x32x16_bf16 v[144:159], a[60:63], a[220:223], v[144:159]
    s_waitcnt vmcnt(12) lgkmcnt(4)
    ds_read_b128 a[208:211], v3 offset:32
    buffer_load_dwordx4 a[116:119], v2, s[48:51], s76 offen offset:1024 sc1
    v_rcp_f32 v216, v216
    v_fma_f32 v227, v210, v222, -v206
    v_lshlrev_b32 v214, 16, v235
    v_fma_f32 v213, v213, v241, v245
    v_exp_f32 v220, v212
    v_fma_f32 v218, v218, s64, v254
    v_mfma_f32_32x32x16_bf16 v[48:63], a[64:67], a[192:195], v[48:63]
    s_waitcnt lgkmcnt(3)
    ds_read_b128 a[212:215], v3 offset:2208
    v_fma_f32 v30, -v211, v223, v203
    v_fma_f32 v31, v211, v223, v207
    v_rcp_f32 v217, v217
    v_fma_f32 v29, v211, v223, -v207
    v_cvt_pk_bf16_f32 v229, v229, v30
    v_cvt_pk_bf16_f32 v231, v231, v31
    v_cvt_pk_bf16_f32 v227, v227, v29
    v_mfma_f32_32x32x16_bf16 v[112:127], a[64:67], a[196:199], v[112:127]
    s_waitcnt vmcnt(12) lgkmcnt(3)
    ds_read_b128 a[216:219], v3 offset:1664
    buffer_load_dwordx4 a[120:123], v2, s[48:51], s76 offen offset:2048 sc1
    ds_write_b64 v7, v[228:229] offset:6560
    ds_write_b64 v7, v[230:231] offset:7104
    v_mfma_f32_32x32x16_bf16 v[64:79], a[68:71], a[200:203], v[64:79]
    s_waitcnt lgkmcnt(5)
    ds_read_b128 a[220:223], v3 offset:3840
    ds_write_b64 v7, v[226:227] offset:7648
    v_and_b32 v215, s78, v235
    v_fma_f32 v214, v214, v242, v246
    v_exp_f32 v221, v213
    v_fma_f32 v219, v219, s64, v254
    v_fma_f32 v232, v192, v216, -v200
    v_rcp_f32 v218, v218
    v_mfma_f32_32x32x16_bf16 v[128:143], a[68:71], a[204:207], v[128:143]
    s_waitcnt vmcnt(12) lgkmcnt(6)
    ds_read_b128 a[192:195], v4 offset:576
    buffer_load_dwordx4 a[124:127], v2, s[48:51], s76 offen offset:3072 sc1
    v_fma_f32 v215, v215, v243, v247
    v_exp_f32_e64 v222, v214
    v_fma_f32 v220, v220, s64, v255
    v_fma_f32 v233, v193, v217, -v201
    v_cvt_pk_bf16_f32 v232, v232, v233
    v_rcp_f32 v219, v219
    v_mfma_f32_32x32x16_bf16 v[32:47], a[72:75], a[208:211], v[32:47]
    s_waitcnt lgkmcnt(6)
    ds_read_b128 a[196:199], v4 offset:2752
    s_add_u32 s76, s76, 4096
    buffer_load_dwordx4 a[128:131], v2, s[48:51], s76 offen offset:0 sc1
    v_exp_f32_e64 v223, v215
    v_fma_f32 v221, v221, s64, v255
    v_fma_f32 v233, v194, v218, -v202
    v_rcp_f32_e64 v220, v220
    v_fma_f32 v222, v222, s64, v255
    v_fma_f32 v30, v195, v219, -v203
    v_mfma_f32_32x32x16_bf16 v[96:111], a[72:75], a[212:215], v[96:111]
    s_waitcnt vmcnt(13) lgkmcnt(6)
    ds_read_b128 a[200:203], v4 offset:1120
    buffer_load_dwordx4 a[132:135], v2, s[48:51], s76 offen offset:1024 sc1
    v_cvt_pk_bf16_f32 v233, v233, v30
    v_rcp_f32 v221, v221
    v_fma_f32 v223, v223, s64, v255
    v_fma_f32 v248, v212, v220, -v204
    v_rcp_f32 v222, v222
    v_fma_f32 v249, v213, v221, -v205
    v_cvt_pk_bf16_f32 v248, v248, v249
    v_mfma_f32_32x32x16_bf16 v[80:95], a[76:79], a[216:219], v[80:95]
    s_waitcnt lgkmcnt(4)
    ds_read_b128 a[204:207], v4 offset:3296
    buffer_load_dwordx4 a[136:139], v2, s[48:51], s76 offen offset:2048 sc1
    ds_write_b64 v7, v[232:233] offset:4384
    v_rcp_f32_e64 v223, v223
    v_fma_f32 v249, v214, v222, -v206
    v_fma_f32 v30, v215, v223, -v207
    v_mfma_f32_32x32x16_bf16 v[144:159], a[76:79], a[220:223], v[144:159]
    s_waitcnt vmcnt(14) lgkmcnt(4)
    ds_read_b128 a[208:211], v4 offset:32
    v_cvt_pk_bf16_f32 v249, v249, v30
    v_mfma_f32_32x32x16_bf16 v[48:63], a[80:83], a[192:195], v[48:63]
    s_waitcnt lgkmcnt(4)
    ds_read_b128 a[212:215], v4 offset:2208
    buffer_load_dwordx4 a[140:143], v2, s[48:51], s76 offen offset:3072 sc1
    ds_write_b64 v7, v[248:249] offset:8192
    ds_read_b128 v[240:243], v11 offset:128
    ds_read_b128 v[244:247], v11 offset:160
    v_mfma_f32_32x32x16_bf16 v[112:127], a[80:83], a[196:199], v[112:127]
    s_waitcnt vmcnt(14) lgkmcnt(7)
    ds_read_b128 a[216:219], v4 offset:1664
    ds_read_b64_tr_b16 v[228:229], v20 offset:576
    ds_read_b64_tr_b16 v[230:231], v20 offset:640
    ds_read_b64_tr_b16 v[226:227], v20 offset:512
    ds_read_b64_tr_b16 v[232:233], v20 offset:704
    ds_read_b64_tr_b16 v[224:225], v21 offset:9024
    ds_read_b64_tr_b16 v[234:235], v21 offset:9088
    v_mfma_f32_32x32x16_bf16 v[64:79], a[84:87], a[200:203], v[64:79]
    s_waitcnt lgkmcnt(9)
    s_barrier
    ds_read_b128 a[220:223], v4 offset:3840
    s_add_u32 s76, s76, 4096
    buffer_load_dwordx4 a[144:147], v2, s[48:51], s76 offen offset:0 sc1
    v_mfma_f32_32x32x16_bf16 v[128:143], a[84:87], a[204:207], v[128:143]
    s_waitcnt vmcnt(14)
    ds_read_b128 a[192:195], v3 offset:4944
    v_mfma_f32_32x32x16_bf16 v[32:47], a[88:91], a[208:211], v[32:47]
    s_waitcnt lgkmcnt(7)
    ds_read_b128 a[196:199], v3 offset:7120
    buffer_load_dwordx4 a[148:151], v2, s[48:51], s76 offen offset:1024 sc1
    v_lshlrev_b32 v200, 16, v228
    v_and_b32 v201, s78, v228
    v_fma_f32 v200, v200, v240, v244
    v_lshlrev_b32 v202, 16, v229
    v_fma_f32 v201, v201, v241, v245
    v_mfma_f32_32x32x16_bf16 v[96:111], a[88:91], a[212:215], v[96:111]
    s_waitcnt vmcnt(14) lgkmcnt(7)
    ds_read_b128 a[200:203], v3 offset:5488
    v_exp_f32 v216, v200
    v_and_b32 v203, s78, v229
    v_fma_f32 v202, v202, v242, v246
    v_exp_f32 v217, v201
    v_lshlrev_b32 v204, 16, v230
    v_mfma_f32_32x32x16_bf16 v[80:95], a[92:95], a[216:219], v[80:95]
    s_waitcnt lgkmcnt(3)
    ds_read_b128 a[204:207], v3 offset:7664
    buffer_load_dwordx4 a[152:155], v2, s[48:51], s76 offen offset:2048 sc1
    v_fma_f32 v203, v203, v243, v247
    v_exp_f32 v218, v202
    v_fma_f32 v216, v216, s64, s64
    v_and_b32 v205, s78, v230
    v_mfma_f32_32x32x16_bf16 v[144:159], a[92:95], a[220:223], v[144:159]
    s_waitcnt vmcnt(14) lgkmcnt(3)
    ds_read_b128 a[208:211], v3 offset:4400
    v_fma_f32 v204, v204, v240, v244
    v_exp_f32 v219, v203
    v_fma_f32 v217, v217, s64, s64
    v_rcp_f32 v216, v216
    v_lshlrev_b32_e64 v206, 16, v231
    v_mfma_f32_32x32x16_bf16 v[48:63], a[96:99], a[192:195], v[48:63]
    s_waitcnt lgkmcnt(3)
    ds_read_b128 a[212:215], v3 offset:6576
    buffer_load_dwordx4 a[156:159], v2, s[48:51], s76 offen offset:3072 sc1
    v_fma_f32 v205, v205, v241, v245
    v_exp_f32_e64 v220, v204
    v_fma_f32 v218, v218, s64, s64
    v_mfma_f32_32x32x16_bf16 v[112:127], a[96:99], a[196:199], v[112:127]
    s_waitcnt vmcnt(14) lgkmcnt(3)
    ds_read_b128 a[216:219], v3 offset:6032
    v_rcp_f32 v217, v217
    v_and_b32_e64 v207, s78, v231
    v_fma_f32 v206, v206, v242, v246
    v_exp_f32 v221, v205
    v_fma_f32 v219, v219, s64, s64
    v_mfma_f32_32x32x16_bf16 v[64:79], a[100:103], a[200:203], v[64:79]
    s_waitcnt lgkmcnt(3)
    ds_read_b128 a[220:223], v3 offset:8208
    s_add_u32 s76, s76, 4096
    buffer_load_dwordx4 a[160:163], v2, s[48:51], s76 offen offset:0 sc1
    v_mul_f32 v200, v200, v216
    v_rcp_f32 v218, v218
    v_lshlrev_b32 v196, 16, v226
    v_mfma_f32_32x32x16_bf16 v[128:143], a[100:103], a[204:207], v[128:143]
    s_waitcnt vmcnt(14) lgkmcnt(3)
    ds_read_b128 a[192:195], v4 offset:4944
    v_fma_f32 v207, v207, v243, v247
    v_exp_f32 v222, v206
    v_fma_f32 v220, v220, s64, s64
    v_mul_f32 v201, v201, v217
    v_rcp_f32 v219, v219
    v_mfma_f32_32x32x16_bf16 v[32:47], a[104:107], a[208:211], v[32:47]
    s_waitcnt lgkmcnt(3)
    ds_read_b128 a[196:199], v4 offset:7120
    buffer_load_dwordx4 a[164:167], v2, s[48:51], s76 offen offset:1024 sc1
    v_and_b32_e64 v197, s78, v226
    v_fma_f32 v196, v196, v240, v244
    v_exp_f32 v223, v207
    v_fma_f32 v221, v221, s64, s64
    v_mfma_f32_32x32x16_bf16 v[96:111], a[104:107], a[212:215], v[96:111]
    s_waitcnt vmcnt(14) lgkmcnt(3)
    ds_read_b128 a[200:203], v4 offset:5488
    buffer_load_dwordx4 a[168:171], v2, s[48:51], s76 offen offset:2048 sc1
    v_mul_f32 v202, v202, v218
    v_rcp_f32 v220, v220
    v_lshlrev_b32_e64 v198, 16, v227
    v_fma_f32 v197, v197, v241, v245
    v_mfma_f32_32x32x16_bf16 v[80:95], a[108:111], a[216:219], v[80:95]
    s_waitcnt lgkmcnt(3)
    ds_read_b128 a[204:207], v4 offset:7664
    v_exp_f32 v216, v196
    v_fma_f32 v222, v222, s64, s64
    v_mul_f32 v203, v203, v219
    v_rcp_f32 v221, v221
    v_and_b32 v199, s78, v227
    v_mfma_f32_32x32x16_bf16 v[144:159], a[108:111], a[220:223], v[144:159]
    s_waitcnt vmcnt(14) lgkmcnt(3)
    ds_read_b128 a[208:211], v4 offset:4400
    buffer_load_dwordx4 a[172:175], v2, s[48:51], s76 offen offset:3072 sc1
    v_fma_f32 v198, v198, v242, v246
    v_exp_f32 v217, v197
    v_fma_f32 v223, v223, s64, s64
    v_mul_f32 v204, v204, v220
    v_mfma_f32_32x32x16_bf16 v[48:63], a[112:115], a[192:195], v[48:63]
    s_waitcnt lgkmcnt(3)
    ds_read_b128 a[212:215], v4 offset:6576
    v_rcp_f32 v222, v222
    v_lshlrev_b32_e64 v208, 16, v232
    v_fma_f32 v199, v199, v243, v247
    v_exp_f32 v218, v198
    v_fma_f32 v216, v216, s64, s64
    v_mfma_f32_32x32x16_bf16 v[112:127], a[112:115], a[196:199], v[112:127]
    s_waitcnt vmcnt(14) lgkmcnt(3)
    ds_read_b128 a[216:219], v4 offset:6032
    s_add_u32 s76, s76, 4096
    buffer_load_dwordx4 a[176:179], v2, s[48:51], s76 offen offset:0 sc1
    v_mul_f32 v205, v205, v221
    v_rcp_f32 v223, v223
    v_and_b32 v209, s78, v232
    v_mfma_f32_32x32x16_bf16 v[64:79], a[116:119], a[200:203], v[64:79]
    s_waitcnt lgkmcnt(3)
    ds_read_b128 a[220:223], v4 offset:8208
    v_fma_f32 v208, v208, v240, v244
    v_exp_f32 v219, v199
    v_fma_f32 v217, v217, s64, s64
    v_mul_f32 v206, v206, v222
    v_rcp_f32 v216, v216
    v_mfma_f32_32x32x16_bf16 v[128:143], a[116:119], a[204:207], v[128:143]
    s_waitcnt vmcnt(14) lgkmcnt(3)
    ds_read_b128 a[192:195], v3 offset:4928
    buffer_load_dwordx4 a[180:183], v2, s[48:51], s76 offen offset:1024 sc1
    v_lshlrev_b32 v210, 16, v233
    v_fma_f32 v209, v209, v241, v245
    v_exp_f32 v220, v208
    v_fma_f32 v218, v218, s64, s64
    v_mfma_f32_32x32x16_bf16 v[32:47], a[120:123], a[208:211], v[32:47]
    s_waitcnt lgkmcnt(3)
    ds_read_b128 a[196:199], v3 offset:7104
    v_mul_f32 v207, v207, v223
    v_rcp_f32 v217, v217
    v_and_b32 v211, s78, v233
    v_fma_f32 v210, v210, v242, v246
    v_exp_f32 v221, v209
    v_mfma_f32_32x32x16_bf16 v[96:111], a[120:123], a[212:215], v[96:111]
    s_waitcnt vmcnt(14) lgkmcnt(3)
    ds_read_b128 a[200:203], v3 offset:5472
    buffer_load_dwordx4 a[184:187], v2, s[48:51], s76 offen offset:2048 sc1
    v_fma_f32 v219, v219, s64, s64
    v_fma_f32 v248, v196, v216, v200
    v_fma_f32 v250, -v196, v216, v200
    v_rcp_f32 v218, v218
    v_mfma_f32_32x32x16_bf16 v[80:95], a[124:127], a[216:219], v[80:95]
    s_waitcnt lgkmcnt(3)
    ds_read_b128 a[204:207], v3 offset:7648
    buffer_load_dwordx4 a[188:191], v2, s[48:51], s76 offen offset:3072 sc1
    v_fma_f32 v252, -v196, v216, v204
    v_lshlrev_b32_e64 v192, 16, v224
    v_fma_f32 v211, v211, v243, v247
    v_exp_f32 v222, v210
    v_mfma_f32_32x32x16_bf16 v[144:159], a[124:127], a[220:223], v[144:159]
    s_waitcnt vmcnt(15) lgkmcnt(3)
    ds_read_b128 a[208:211], v3 offset:4384
    v_fma_f32 v220, v220, s64, s64
    v_fma_f32 v249, v197, v217, v201
    v_fma_f32 v251, -v197, v217, v201
    v_rcp_f32_e64 v219, v219
    v_fma_f32 v253, -v197, v217, v205
    v_cvt_pk_bf16_f32 v248, v248, v249
    v_mfma_f32_32x32x16_bf16 v[48:63], a[128:131], a[192:195], v[48:63]
    s_waitcnt lgkmcnt(3)
    ds_read_b128 a[212:215], v3 offset:6560
    s_add_u32 s76, s76, 4096
    buffer_load_dwordx4 a[0:3], v2, s[48:51], s76 offen offset:0 sc1
    v_cvt_pk_bf16_f32 v250, v250, v251
    v_cvt_pk_bf16_f32 v252, v252, v253
    v_and_b32 v193, s78, v224
    v_fma_f32 v192, v192, v240, v244
    v_mfma_f32_32x32x16_bf16 v[112:127], a[128:131], a[196:199], v[112:127]
    s_waitcnt vmcnt(15) lgkmcnt(3)
    ds_read_b128 a[216:219], v3 offset:6016
    v_exp_f32 v223, v211
    v_fma_f32 v221, v221, s64, s64
    v_fma_f32 v249, v198, v218, v202
    v_fma_f32 v251, -v198, v218, v202
    v_rcp_f32_e64 v220, v220
    v_mfma_f32_32x32x16_bf16 v[64:79], a[132:135], a[200:203], v[64:79]
    s_waitcnt lgkmcnt(3)
    ds_read_b128 a[220:223], v3 offset:8192
    buffer_load_dwordx4 a[4:7], v2, s[48:51], s76 offen offset:1024 sc1
    v_fma_f32 v253, -v198, v218, v206
    v_lshlrev_b32 v194, 16, v225
    v_fma_f32 v193, v193, v241, v245
    v_exp_f32 v216, v192
    v_mfma_f32_32x32x16_bf16 v[128:143], a[132:135], a[204:207], v[128:143]
    s_waitcnt vmcnt(15) lgkmcnt(3)
    ds_read_b128 a[192:195], v4 offset:4928
    v_fma_f32 v222, v222, s64, s64
    v_fma_f32 v30, v199, v219, v203
    v_fma_f32 v31, -v199, v219, v203
    v_rcp_f32 v221, v221
    v_fma_f32 v29, -v199, v219, v207
    v_cvt_pk_bf16_f32 v249, v249, v30
    v_mfma_f32_32x32x16_bf16 v[32:47], a[136:139], a[208:211], v[32:47]
    s_waitcnt lgkmcnt(3)
    ds_read_b128 a[196:199], v4 offset:7104
    buffer_load_dwordx4 a[8:11], v2, s[48:51], s76 offen offset:2048 sc1
    ds_write_b64 v7, v[248:249] offset:9312
    v_cvt_pk_bf16_f32 v251, v251, v31
    v_cvt_pk_bf16_f32 v253, v253, v29
    v_mfma_f32_32x32x16_bf16 v[96:111], a[136:139], a[212:215], v[96:111]
    s_waitcnt vmcnt(15) lgkmcnt(4)
    ds_read_b128 a[200:203], v4 offset:5472
    ds_write_b64 v7, v[250:251] offset:9856
    ds_write_b64 v7, v[252:253] offset:10400
    v_and_b32_e64 v195, s78, v225
    v_mfma_f32_32x32x16_bf16 v[80:95], a[140:143], a[216:219], v[80:95]
    s_waitcnt lgkmcnt(6)
    ds_read_b128 a[204:207], v4 offset:7648
    buffer_load_dwordx4 a[12:15], v2, s[48:51], s76 offen offset:3072 sc1
    v_fma_f32 v194, v194, v242, v246
    v_exp_f32_e64 v217, v193
    v_fma_f32 v223, v223, s64, s64
    v_fma_f32 v228, -v208, v220, v200
    v_mfma_f32_32x32x16_bf16 v[144:159], a[140:143], a[220:223], v[144:159]
    s_waitcnt vmcnt(15) lgkmcnt(6)
    ds_read_b128 a[208:211], v4 offset:4384
    s_add_u32 s76, s76, 4096
    buffer_load_dwordx4 a[16:19], v2, s[48:51], s76 offen offset:0 sc1
    v_fma_f32 v230, v208, v220, v204
    v_rcp_f32 v222, v222
    v_fma_f32 v226, v208, v220, -v204
    v_mfma_f32_32x32x16_bf16 v[48:63], a[144:147], a[192:195], v[48:63]
    s_waitcnt lgkmcnt(6)
    ds_read_b128 a[212:215], v4 offset:6560
    v_lshlrev_b32 v212, 16, v234
    v_fma_f32 v195, v195, v243, v247
    v_exp_f32_e64 v218, v194
    v_fma_f32 v216, v216, s64, v254
    v_fma_f32 v229, -v209, v221, v201
    v_fma_f32 v231, v209, v221, v205
    v_mfma_f32_32x32x16_bf16 v[112:127], a[144:147], a[196:199], v[112:127]
    s_waitcnt vmcnt(15) lgkmcnt(5)
    ds_read_b128 a[216:219], v4 offset:6016
    buffer_load_dwordx4 a[20:23], v2, s[48:51], s76 offen offset:1024 sc1
    v_rcp_f32 v223, v223
    v_fma_f32 v227, v209, v221, -v205
    v_cvt_pk_bf16_f32 v228, v228, v229
    v_cvt_pk_bf16_f32 v230, v230, v231
    v_mfma_f32_32x32x16_bf16 v[64:79], a[148:151], a[200:203], v[64:79]
    s_waitcnt lgkmcnt(3)
    ds_read_b128 a[220:223], v4 offset:8192
    v_cvt_pk_bf16_f32 v226, v226, v227
    v_and_b32 v213, s78, v234
    v_fma_f32 v212, v212, v240, v244
    v_exp_f32_e64 v219, v195
    v_fma_f32 v217, v217, s64, v254
    v_fma_f32 v229, -v210, v222, v202
    v_mfma_f32_32x32x16_bf16 v[128:143], a[148:151], a[204:207], v[128:143]
    s_waitcnt vmcnt(15) lgkmcnt(3)
    ds_read_b128 a[192:195], v3 offset:4960
    buffer_load_dwordx4 a[24:27], v2, s[48:51], s76 offen offset:2048 sc1
    v_fma_f32 v231, v210, v222, v206
    v_rcp_f32 v216, v216
    v_fma_f32 v227, v210, v222, -v206
    v_lshlrev_b32 v214, 16, v235
    v_mfma_f32_32x32x16_bf16 v[32:47], a[152:155], a[208:211], v[32:47]
    s_waitcnt lgkmcnt(3)
    ds_read_b128 a[196:199], v3 offset:7136
    v_fma_f32 v213, v213, v241, v245
    v_exp_f32_e64 v220, v212
    v_fma_f32 v218, v218, s64, v254
    v_fma_f32 v30, -v211, v223, v203
    v_fma_f32 v31, v211, v223, v207
    v_mfma_f32_32x32x16_bf16 v[96:111], a[152:155], a[212:215], v[96:111]
    s_waitcnt vmcnt(15) lgkmcnt(3)
    ds_read_b128 a[200:203], v3 offset:5504
    buffer_load_dwordx4 a[28:31], v2, s[48:51], s76 offen offset:3072 sc1
    v_rcp_f32 v217, v217
    v_fma_f32 v29, v211, v223, -v207
    v_cvt_pk_bf16_f32 v229, v229, v30
    v_cvt_pk_bf16_f32 v231, v231, v31
    v_mfma_f32_32x32x16_bf16 v[80:95], a[156:159], a[216:219], v[80:95]
    s_waitcnt lgkmcnt(3)
    ds_read_b128 a[204:207], v3 offset:7680
    ds_write_b64 v7, v[228:229] offset:10944
    ds_write_b64 v7, v[230:231] offset:11488
    v_cvt_pk_bf16_f32 v227, v227, v29
    v_mfma_f32_32x32x16_bf16 v[144:159], a[156:159], a[220:223], v[144:159]
    s_waitcnt vmcnt(15) lgkmcnt(5)
    ds_read_b128 a[208:211], v3 offset:4416
    s_add_u32 s76, s76, 4096
    buffer_load_dwordx4 a[32:35], v2, s[48:51], s76 offen offset:0 sc1
    ds_write_b64 v7, v[226:227] offset:12032
    v_and_b32 v215, s78, v235
    v_mfma_f32_32x32x16_bf16 v[48:63], a[160:163], a[192:195], v[48:63]
    s_waitcnt lgkmcnt(6)
    ds_read_b128 a[212:215], v3 offset:6592
    v_fma_f32 v214, v214, v242, v246
    v_exp_f32 v221, v213
    v_fma_f32 v219, v219, s64, v254
    v_fma_f32 v232, v192, v216, -v200
    v_rcp_f32 v218, v218
    v_fma_f32 v215, v215, v243, v247
    v_mfma_f32_32x32x16_bf16 v[112:127], a[160:163], a[196:199], v[112:127]
    s_waitcnt vmcnt(15) lgkmcnt(6)
    ds_read_b128 a[216:219], v3 offset:6048
    buffer_load_dwordx4 a[36:39], v2, s[48:51], s76 offen offset:1024 sc1
    v_exp_f32 v222, v214
    v_fma_f32 v220, v220, s64, v255
    v_fma_f32 v233, v193, v217, -v201
    v_cvt_pk_bf16_f32 v232, v232, v233
    v_mfma_f32_32x32x16_bf16 v[64:79], a[164:167], a[200:203], v[64:79]
    s_waitcnt lgkmcnt(6)
    ds_read_b128 a[220:223], v3 offset:8224
    buffer_load_dwordx4 a[40:43], v2, s[48:51], s76 offen offset:2048 sc1
    v_rcp_f32 v219, v219
    v_exp_f32_e64 v223, v215
    v_fma_f32 v221, v221, s64, v255
    v_mfma_f32_32x32x16_bf16 v[128:143], a[164:167], a[204:207], v[128:143]
    s_waitcnt vmcnt(16) lgkmcnt(4)
    ds_read_b128 a[192:195], v4 offset:4960
    v_fma_f32 v233, v194, v218, -v202
    v_rcp_f32 v220, v220
    v_fma_f32 v222, v222, s64, v255
    v_fma_f32 v30, v195, v219, -v203
    v_cvt_pk_bf16_f32 v233, v233, v30
    v_rcp_f32 v221, v221
    v_mfma_f32_32x32x16_bf16 v[32:47], a[168:171], a[208:211], v[32:47]
    s_waitcnt lgkmcnt(3)
    ds_read_b128 a[196:199], v4 offset:7136
    buffer_load_dwordx4 a[44:47], v2, s[48:51], s76 offen offset:3072 sc1
    ds_write_b64 v7, v[232:233] offset:8768
    v_fma_f32 v223, v223, s64, v255
    v_mfma_f32_32x32x16_bf16 v[96:111], a[168:171], a[212:215], v[96:111]
    s_waitcnt vmcnt(16) lgkmcnt(4)
    ds_read_b128 a[200:203], v4 offset:5504
    v_fma_f32 v248, v212, v220, -v204
    v_rcp_f32 v222, v222
    v_fma_f32 v249, v213, v221, -v205
    v_cvt_pk_bf16_f32 v248, v248, v249
    v_rcp_f32 v223, v223
    v_fma_f32 v249, v214, v222, -v206
    v_mfma_f32_32x32x16_bf16 v[80:95], a[172:175], a[216:219], v[80:95]
    s_waitcnt lgkmcnt(4)
    ds_read_b128 a[204:207], v4 offset:7680
    s_add_u32 s76, s76, 4096
    buffer_load_dwordx4 a[48:51], v2, s[48:51], s76 offen offset:0 sc1
    v_fma_f32 v30, v215, v223, -v207
    v_cvt_pk_bf16_f32 v249, v249, v30
    v_mfma_f32_32x32x16_bf16 v[144:159], a[172:175], a[220:223], v[144:159]
    s_waitcnt vmcnt(16) lgkmcnt(4)
    ds_read_b128 a[208:211], v4 offset:4416
    ds_write_b64 v7, v[248:249] offset:12576
    ds_read_b128 v[240:243], v11 offset:192
    ds_read_b128 v[244:247], v11 offset:224
    ds_read_b64_tr_b16 v[228:229], v20 offset:832
    ds_read_b64_tr_b16 v[230:231], v20 offset:896
    v_mfma_f32_32x32x16_bf16 v[48:63], a[176:179], a[192:195], v[48:63]
    s_waitcnt lgkmcnt(9)
    ds_read_b128 a[212:215], v4 offset:6592
    buffer_load_dwordx4 a[52:55], v2, s[48:51], s76 offen offset:1024 sc1
    ds_read_b64_tr_b16 v[226:227], v20 offset:768
    ds_read_b64_tr_b16 v[232:233], v20 offset:960
    ds_read_b64_tr_b16 v[224:225], v21 offset:9152
    ds_read_b64_tr_b16 v[234:235], v21 offset:9216
    v_mfma_f32_32x32x16_bf16 v[112:127], a[176:179], a[196:199], v[112:127]
    s_waitcnt vmcnt(16) lgkmcnt(12)
    ds_read_b128 a[216:219], v4 offset:6048
    s_mul_i32 s10, s4, 12288
    s_lshl_b32 s11, s3, 7
    s_add_u32 s10, s10, s11
    s_add_u32 s10, s10, 0x10000
    s_add_u32 s12, s10, 4096
    s_add_u32 s13, s10, 8192
    v_mfma_f32_32x32x16_bf16 v[64:79], a[180:183], a[200:203], v[64:79]
    s_waitcnt lgkmcnt(10)
    s_barrier
    ds_read_b128 a[220:223], v4 offset:8224
    buffer_load_dwordx4 a[56:59], v2, s[48:51], s76 offen offset:2048 sc1
    buffer_load_dwordx4 v[176:179], v18, s[48:51], s10 offen sc1
    buffer_load_dwordx4 v[180:183], v18, s[48:51], s12 offen sc1
    v_mfma_f32_32x32x16_bf16 v[128:143], a[180:183], a[204:207], v[128:143]
    s_waitcnt vmcnt(18) lgkmcnt(8)
    ds_read_b128 a[192:195], v3 offset:9328
    buffer_load_dwordx4 v[184:187], v18, s[48:51], s13 offen sc1
    v_lshlrev_b32 v200, 16, v228
    v_and_b32 v201, s78, v228
    v_fma_f32 v200, v200, v240, v244
    v_lshlrev_b32_e64 v202, 16, v229
    v_fma_f32 v201, v201, v241, v245
    v_mfma_f32_32x32x16_bf16 v[32:47], a[184:187], a[208:211], v[32:47]
    s_waitcnt lgkmcnt(7)
    ds_read_b128 a[196:199], v3 offset:11504
    buffer_load_dwordx4 a[60:63], v2, s[48:51], s76 offen offset:3072 sc1
    v_exp_f32 v216, v200
    v_and_b32 v203, s78, v229
    v_fma_f32 v202, v202, v242, v246
    v_mfma_f32_32x32x16_bf16 v[96:111], a[184:187], a[212:215], v[96:111]
    s_waitcnt vmcnt(19) lgkmcnt(3)
    ds_read_b128 a[200:203], v3 offset:9872
    s_add_u32 s76, s76, 4096
    buffer_load_dwordx4 a[64:67], v2, s[48:51], s76 offen offset:0 sc1
    v_exp_f32 v217, v201
    v_lshlrev_b32 v204, 16, v230
    v_fma_f32 v203, v203, v243, v247
    v_mfma_f32_32x32x16_bf16 v[80:95], a[188:191], a[216:219], v[80:95]
L_hop2:
    s_cbranch_execz L_hop6
    s_waitcnt lgkmcnt(3)
    ds_read_b128 a[204:207], v3 offset:12048
    v_exp_f32_e64 v218, v202
    v_fma_f32 v216, v216, s64, s64
    v_and_b32 v205, s78, v230
    v_fma_f32 v204, v204, v240, v244
    v_exp_f32 v219, v203
    v_mfma_f32_32x32x16_bf16 v[144:159], a[188:191], a[220:223], v[144:159]
    s_waitcnt vmcnt(19) lgkmcnt(3)
    ds_read_b128 a[208:211], v3 offset:8784
    buffer_load_dwordx4 a[68:71], v2, s[48:51], s76 offen offset:1024 sc1
    v_fma_f32 v217, v217, s64, s64
    v_rcp_f32 v216, v216
    v_lshlrev_b32 v206, 16, v231
    v_fma_f32 v205, v205, v241, v245
    v_mfma_f32_32x32x16_bf16 v[48:63], a[0:3], a[192:195], v[48:63]
    s_waitcnt lgkmcnt(3)
    ds_read_b128 a[212:215], v3 offset:10960
    v_exp_f32 v220, v204
    v_fma_f32 v218, v218, s64, s64
    v_rcp_f32 v217, v217
    v_and_b32_e64 v207, s78, v231
    v_fma_f32 v206, v206, v242, v246
    v_mfma_f32_32x32x16_bf16 v[112:127], a[0:3], a[196:199], v[112:127]
    s_waitcnt vmcnt(19) lgkmcnt(3)
    ds_read_b128 a[216:219], v3 offset:10416
    buffer_load_dwordx4 a[72:75], v2, s[48:51], s76 offen offset:2048 sc1
    v_exp_f32 v221, v205
    v_fma_f32 v219, v219, s64, s64
    v_mul_f32 v200, v200, v216
    v_mfma_f32_32x32x16_bf16 v[64:79], a[4:7], a[200:203], v[64:79]
    s_waitcnt lgkmcnt(3)
    ds_read_b128 a[220:223], v3 offset:12592
    v_rcp_f32 v218, v218
    v_lshlrev_b32 v196, 16, v226
    v_fma_f32 v207, v207, v243, v247
    v_exp_f32_e64 v222, v206
    v_fma_f32 v220, v220, s64, s64
    v_mfma_f32_32x32x16_bf16 v[128:143], a[4:7], a[204:207], v[128:143]
    s_waitcnt vmcnt(19) lgkmcnt(3)
    ds_read_b128 a[192:195], v4 offset:9328
    buffer_load_dwordx4 a[76:79], v2, s[48:51], s76 offen offset:3072 sc1
    v_mul_f32 v201, v201, v217
    v_rcp_f32 v219, v219
    v_and_b32_e64 v197, s78, v226
    v_fma_f32 v196, v196, v240, v244
    v_mfma_f32_32x32x16_bf16 v[32:47], a[8:11], a[208:211], v[32:47]
    s_waitcnt lgkmcnt(3)
    ds_read_b128 a[196:199], v4 offset:11504
    v_exp_f32 v223, v207
    v_fma_f32 v221, v221, s64, s64
    v_mul_f32 v202, v202, v218
    v_rcp_f32_e64 v220, v220
    v_lshlrev_b32 v198, 16, v227
    v_mfma_f32_32x32x16_bf16 v[96:111], a[8:11], a[212:215], v[96:111]
    s_waitcnt vmcnt(19) lgkmcnt(3)
    ds_read_b128 a[200:203], v4 offset:9872
    s_add_u32 s76, s76, 4096
    buffer_load_dwordx4 a[80:83], v2, s[48:51], s76 offen offset:0 sc1
    v_fma_f32 v197, v197, v241, v245
    v_exp_f32_e64 v216, v196
    v_fma_f32 v222, v222, s64, s64
    v_mfma_f32_32x32x16_bf16 v[80:95], a[12:15], a[216:219], v[80:95]
    s_waitcnt lgkmcnt(3)
    ds_read_b128 a[204:207], v4 offset:12048
    v_mul_f32 v203, v203, v219
    v_rcp_f32 v221, v221
    v_and_b32 v199, s78, v227
    v_fma_f32 v198, v198, v242, v246
    v_exp_f32 v217, v197
    v_mfma_f32_32x32x16_bf16 v[144:159], a[12:15], a[220:223], v[144:159]
    s_waitcnt vmcnt(19) lgkmcnt(3)
    ds_read_b128 a[208:211], v4 offset:8784
    buffer_load_dwordx4 a[84:87], v2, s[48:51], s76 offen offset:1024 sc1
    v_fma_f32 v223, v223, s64, s64
    v_mul_f32 v204, v204, v220
    v_rcp_f32 v222, v222
    v_lshlrev_b32_e64 v208, 16, v232
    v_mfma_f32_32x32x16_bf16 v[48:63], a[16:19], a[192:195], v[48:63]
    s_waitcnt lgkmcnt(3)
    ds_read_b128 a[212:215], v4 offset:10960
    buffer_load_dwordx4 a[88:91], v2, s[48:51], s76 offen offset:2048 sc1
    v_fma_f32 v199, v199, v243, v247
    v_exp_f32 v218, v198
    v_fma_f32 v216, v216, s64, s64
    v_mul_f32 v205, v205, v221
    v_mfma_f32_32x32x16_bf16 v[112:127], a[16:19], a[196:199], v[112:127]
    s_waitcnt vmcnt(20) lgkmcnt(3)
    ds_read_b128 a[216:219], v4 offset:10416
    v_rcp_f32 v223, v223
    v_and_b32 v209, s78, v232
    v_fma_f32 v208, v208, v240, v244
    v_exp_f32_e64 v219, v199
    v_fma_f32 v217, v217, s64, s64
    v_mfma_f32_32x32x16_bf16 v[64:79], a[20:23], a[200:203], v[64:79]
    s_waitcnt lgkmcnt(3)
    ds_read_b128 a[220:223], v4 offset:12592
    buffer_load_dwordx4 a[92:95], v2, s[48:51], s76 offen offset:3072 sc1
    v_mul_f32 v206, v206, v222
    v_rcp_f32 v216, v216
    v_lshlrev_b32 v210, 16, v233
    v_fma_f32 v209, v209, v241, v245
    v_mfma_f32_32x32x16_bf16 v[128:143], a[20:23], a[204:207], v[128:143]
    s_waitcnt vmcnt(20) lgkmcnt(3)
    ds_read_b128 a[192:195], v3 offset:9312
    v_exp_f32 v220, v208
    v_fma_f32 v218, v218, s64, s64
    v_mul_f32 v207, v207, v223
    v_rcp_f32 v217, v217
    v_and_b32 v211, s78, v233
    v_mfma_f32_32x32x16_bf16 v[32:47], a[24:27], a[208:211], v[32:47]
    s_waitcnt lgkmcnt(3)
    ds_read_b128 a[196:199], v3 offset:11488
    s_add_u32 s76, s76, 4096
    buffer_load_dwordx4 a[96:99], v2, s[48:51], s76 offen offset:0 sc1
    v_fma_f32 v210, v210, v242, v246
    v_exp_f32_e64 v221, v209
    v_fma_f32 v219, v219, s64, s64
    v_mfma_f32_32x32x16_bf16 v[96:111], a[24:27], a[212:215], v[96:111]
    s_waitcnt vmcnt(20) lgkmcnt(3)
    ds_read_b128 a[200:203], v3 offset:9856
    v_fma_f32 v248, v196, v216, v200
    v_fma_f32 v250, -v196, v216, v200
    v_rcp_f32 v218, v218
    v_fma_f32 v252, -v196, v216, v204
    v_lshlrev_b32_e64 v192, 16, v224
    v_fma_f32 v211, v211, v243, v247
    v_mfma_f32_32x32x16_bf16 v[80:95], a[28:31], a[216:219], v[80:95]
    s_waitcnt lgkmcnt(3)
    ds_read_b128 a[204:207], v3 offset:12032
    buffer_load_dwordx4 a[100:103], v2, s[48:51], s76 offen offset:1024 sc1
    v_exp_f32 v222, v210
    v_fma_f32 v220, v220, s64, s64
    v_fma_f32 v249, v197, v217, v201
    v_fma_f32 v251, -v197, v217, v201
    v_mfma_f32_32x32x16_bf16 v[144:159], a[28:31], a[220:223], v[144:159]
    s_waitcnt vmcnt(20) lgkmcnt(3)
    ds_read_b128 a[208:211], v3 offset:8768
    v_rcp_f32 v219, v219
    v_fma_f32 v253, -v197, v217, v205
    v_cvt_pk_bf16_f32 v248, v248, v249
    v_cvt_pk_bf16_f32 v250, v250, v251
    v_cvt_pk_bf16_f32 v252, v252, v253
    v_and_b32 v193, s78, v224
    v_mfma_f32_32x32x16_bf16 v[48:63], a[32:35], a[192:195], v[48:63]
    s_waitcnt lgkmcnt(3)
    ds_read_b128 a[212:215], v3 offset:10944
    buffer_load_dwordx4 a[104:107], v2, s[48:51], s76 offen offset:2048 sc1
    v_fma_f32 v192, v192, v240, v244
    v_exp_f32_e64 v223, v211
    v_fma_f32 v221, v221, s64, s64
    v_fma_f32 v249, v198, v218, v202
    v_mfma_f32_32x32x16_bf16 v[112:127], a[32:35], a[196:199], v[112:127]
    s_waitcnt vmcnt(20) lgkmcnt(3)
    ds_read_b128 a[216:219], v3 offset:10400
    buffer_load_dwordx4 a[108:111], v2, s[48:51], s76 offen offset:3072 sc1
    v_fma_f32 v251, -v198, v218, v202
    v_rcp_f32 v220, v220
    v_fma_f32 v253, -v198, v218, v206
    v_lshlrev_b32 v194, 16, v225
    v_mfma_f32_32x32x16_bf16 v[64:79], a[36:39], a[200:203], v[64:79]
    s_waitcnt lgkmcnt(3)
    ds_read_b128 a[220:223], v3 offset:12576
    v_fma_f32 v193, v193, v241, v245
    v_exp_f32_e64 v216, v192
    v_fma_f32 v222, v222, s64, s64
    v_fma_f32 v30, v199, v219, v203
    v_fma_f32 v31, -v199, v219, v203
    v_mfma_f32_32x32x16_bf16 v[128:143], a[36:39], a[204:207], v[128:143]
    s_waitcnt vmcnt(20) lgkmcnt(3)
    ds_read_b128 a[192:195], v4 offset:9312
    s_add_u32 s76, s76, 4096
    buffer_load_dwordx4 a[112:115], v2, s[48:51], s76 offen offset:0 sc1
    v_rcp_f32 v221, v221
    v_fma_f32 v29, -v199, v219, v207
    v_cvt_pk_bf16_f32 v249, v249, v30
    v_mfma_f32_32x32x16_bf16 v[32:47], a[40:43], a[208:211], v[32:47]
    s_waitcnt lgkmcnt(3)
    ds_read_b128 a[196:199], v4 offset:11488
    ds_write_b64 v7, v[248:249] offset:13696
    v_cvt_pk_bf16_f32 v251, v251, v31
    v_cvt_pk_bf16_f32 v253, v253, v29
    v_and_b32_e64 v195, s78, v225
    v_fma_f32 v194, v194, v242, v246
    v_mfma_f32_32x32x16_bf16 v[96:111], a[40:43], a[212:215], v[96:111]
    s_waitcnt vmcnt(20) lgkmcnt(4)
    ds_read_b128 a[200:203], v4 offset:9856
    buffer_load_dwordx4 a[116:119], v2, s[48:51], s76 offen offset:1024 sc1
    ds_write_b64 v7, v[250:251] offset:14240
    ds_write_b64 v7, v[252:253] offset:14784
    v_mfma_f32_32x32x16_bf16 v[80:95], a[44:47], a[216:219], v[80:95]
    s_waitcnt lgkmcnt(6)
    ds_read_b128 a[204:207], v4 offset:12032
    v_exp_f32 v217, v193
    v_fma_f32 v223, v223, s64, s64
    v_fma_f32 v228, -v208, v220, v200
    v_fma_f32 v230, v208, v220, v204
    v_rcp_f32 v222, v222
    v_mfma_f32_32x32x16_bf16 v[144:159], a[44:47], a[220:223], v[144:159]
    s_waitcnt vmcnt(20) lgkmcnt(6)
    ds_read_b128 a[208:211], v4 offset:8768
    buffer_load_dwordx4 a[120:123], v2, s[48:51], s76 offen offset:2048 sc1
    v_fma_f32 v226, v208, v220, -v204
    v_lshlrev_b32_e64 v212, 16, v234
    v_fma_f32 v195, v195, v243, v247
    v_exp_f32 v218, v194
    v_mfma_f32_32x32x16_bf16 v[48:63], a[48:51], a[192:195], v[48:63]
    s_waitcnt lgkmcnt(6)
    ds_read_b128 a[212:215], v4 offset:10944
    v_fma_f32 v216, v216, s64, v254
    v_fma_f32 v229, -v209, v221, v201
    v_fma_f32 v231, v209, v221, v205
    v_rcp_f32_e64 v223, v223
    v_fma_f32 v227, v209, v221, -v205
    v_cvt_pk_bf16_f32 v228, v228, v229
    v_mfma_f32_32x32x16_bf16 v[112:127], a[48:51], a[196:199], v[112:127]
    s_waitcnt vmcnt(20) lgkmcnt(5)
    ds_read_b128 a[216:219], v4 offset:10400
    buffer_load_dwordx4 a[124:127], v2, s[48:51], s76 offen offset:3072 sc1
    v_cvt_pk_bf16_f32 v230, v230, v231
    v_cvt_pk_bf16_f32 v226, v226, v227
    v_and_b32 v213, s78, v234
    v_fma_f32 v212, v212, v240, v244
    v_mfma_f32_32x32x16_bf16 v[64:79], a[52:55], a[200:203], v[64:79]
    s_waitcnt lgkmcnt(3)
    ds_read_b128 a[220:223], v4 offset:12576
    s_add_u32 s76, s76, 4096
    buffer_load_dwordx4 a[128:131], v2, s[48:51], s76 offen offset:0 sc1
    v_exp_f32 v219, v195
    v_fma_f32 v217, v217, s64, v254
    v_fma_f32 v229, -v210, v222, v202
    v_mfma_f32_32x32x16_bf16 v[128:143], a[52:55], a[204:207], v[128:143]
    s_waitcnt vmcnt(21) lgkmcnt(3)
    ds_read_b128 a[192:195], v3 offset:9344
    v_fma_f32 v231, v210, v222, v206
    v_rcp_f32 v216, v216
    v_fma_f32 v227, v210, v222, -v206
    v_lshlrev_b32 v214, 16, v235
    v_fma_f32 v213, v213, v241, v245
    v_mfma_f32_32x32x16_bf16 v[32:47], a[56:59], a[208:211], v[32:47]
    s_waitcnt lgkmcnt(3)
    ds_read_b128 a[196:199], v3 offset:11520
    buffer_load_dwordx4 a[132:135], v2, s[48:51], s76 offen offset:1024 sc1
    v_exp_f32_e64 v220, v212
    v_fma_f32 v218, v218, s64, v254
    v_fma_f32 v30, -v211, v223, v203
    v_fma_f32 v31, v211, v223, v207
    v_mfma_f32_32x32x16_bf16 v[96:111], a[56:59], a[212:215], v[96:111]
    s_waitcnt vmcnt(18) lgkmcnt(3)
    ds_read_b128 a[200:203], v3 offset:9888
    v_rcp_f32 v217, v217
    v_fma_f32 v29, v211, v223, -v207
    v_cvt_pk_bf16_f32 v229, v229, v30
    v_cvt_pk_bf16_f32 v231, v231, v31
    v_cvt_pk_bf16_f32 v227, v227, v29
    v_mfma_f32_32x32x16_bf16 v[80:95], a[60:63], a[216:219], v[80:95]
    s_waitcnt lgkmcnt(3)
    ds_read_b128 a[204:207], v3 offset:12064
    buffer_load_dwordx4 a[136:139], v2, s[48:51], s76 offen offset:2048 sc1
    ds_write_b64 v7, v[228:229] offset:15328
    ds_write_b64 v7, v[230:231] offset:15872
    v_mfma_f32_32x32x16_bf16 v[144:159], a[60:63], a[220:223], v[144:159]
    s_waitcnt vmcnt(18) lgkmcnt(5)
    ds_read_b128 a[208:211], v3 offset:8800
    ds_write_b64 v7, v[226:227] offset:16416
    v_and_b32_e64 v215, s78, v235
    v_fma_f32 v214, v214, v242, v246
    v_exp_f32 v221, v213
    v_mfma_f32_32x32x16_bf16 v[48:63], a[64:67], a[192:195], v[48:63]
    s_waitcnt lgkmcnt(6)
    ds_read_b128 a[212:215], v3 offset:10976
    buffer_load_dwordx4 a[140:143], v2, s[48:51], s76 offen offset:3072 sc1
    v_fma_f32 v219, v219, s64, v254
    v_fma_f32 v232, v192, v216, -v200
    v_rcp_f32_e64 v218, v218
    v_fma_f32 v215, v215, v243, v247
    v_mfma_f32_32x32x16_bf16 v[112:127], a[64:67], a[196:199], v[112:127]
    s_waitcnt vmcnt(18) lgkmcnt(6)
    ds_read_b128 a[216:219], v3 offset:10432
    v_exp_f32 v222, v214
    v_fma_f32 v220, v220, s64, v255
    v_fma_f32 v233, v193, v217, -v201
    v_cvt_pk_bf16_f32 v232, v232, v233
    v_rcp_f32 v219, v219
    v_mfma_f32_32x32x16_bf16 v[64:79], a[68:71], a[200:203], v[64:79]
    s_waitcnt lgkmcnt(6)
    ds_read_b128 a[220:223], v3 offset:12608
    s_add_u32 s76, s76, 4096
    buffer_load_dwordx4 a[144:147], v2, s[48:51], s76 offen offset:0 sc1
    v_exp_f32_e64 v223, v215
    v_fma_f32 v221, v221, s64, v255
    v_fma_f32 v233, v194, v218, -v202
    v_mfma_f32_32x32x16_bf16 v[128:143], a[68:71], a[204:207], v[128:143]
    s_waitcnt vmcnt(18) lgkmcnt(4)
    ds_read_b128 a[192:195], v4 offset:9344
    v_rcp_f32 v220, v220
    v_fma_f32 v222, v222, s64, v255
    v_fma_f32 v30, v195, v219, -v203
    v_cvt_pk_bf16_f32 v233, v233, v30
    v_rcp_f32 v221, v221
    v_mfma_f32_32x32x16_bf16 v[32:47], a[72:75], a[208:211], v[32:47]
    s_waitcnt lgkmcnt(3)
    ds_read_b128 a[196:199], v4 offset:11520
    buffer_load_dwordx4 a[148:151], v2, s[48:51], s76 offen offset:1024 sc1
    ds_write_b64 v7, v[232:233] offset:13152
    v_fma_f32 v223, v223, s64, v255
    v_mfma_f32_32x32x16_bf16 v[96:111], a[72:75], a[212:215], v[96:111]
    s_waitcnt vmcnt(18) lgkmcnt(4)
    ds_read_b128 a[200:203], v4 offset:9888
    buffer_load_dwordx4 a[152:155], v2, s[48:51], s76 offen offset:2048 sc1
    v_fma_f32 v248, v212, v220, -v204
    v_rcp_f32 v222, v222
    v_fma_f32 v249, v213, v221, -v205
    v_cvt_pk_bf16_f32 v248, v248, v249
    v_mfma_f32_32x32x16_bf16 v[80:95], a[76:79], a[216:219], v[80:95]
    s_waitcnt lgkmcnt(4)
    ds_read_b128 a[204:207], v4 offset:12064
    v_rcp_f32 v223, v223
    v_fma_f32 v249, v214, v222, -v206
    v_fma_f32 v30, v215, v223, -v207
    v_cvt_pk_bf16_f32 v249, v249, v30
    v_mfma_f32_32x32x16_bf16 v[144:159], a[76:79], a[220:223], v[144:159]
    s_waitcnt vmcnt(18) lgkmcnt(4)
    ds_read_b128 a[208:211], v4 offset:8800
    buffer_load_dwordx4 a[156:159], v2, s[48:51], s76 offen offset:3072 sc1
    ds_write_b64 v7, v[248:249] offset:16960
    v_mfma_f32_32x32x16_bf16 v[48:63], a[80:83], a[192:195], v[48:63]
    s_waitcnt lgkmcnt(5)
    ds_read_b128 a[212:215], v4 offset:10976
    v_add_f32 v192, v176, v180
    v_add_f32 v193, v177, v181
    v_add_f32 v194, v178, v182
    v_add_f32 v195, v179, v183
    v_add_f32 v192, v192, v184
    v_mfma_f32_32x32x16_bf16 v[112:127], a[80:83], a[196:199], v[112:127]
    s_waitcnt vmcnt(18) lgkmcnt(4)
    ds_read_b128 a[216:219], v4 offset:10432
    v_add_f32 v193, v193, v185
    v_add_f32 v194, v194, v186
    v_add_f32 v195, v195, v187
    v_and_b32_e64 v204, 7, v1
    v_lshrrev_b32 v205, 4, v1
    v_mfma_f32_32x32x16_bf16 v[64:79], a[84:87], a[200:203], v[64:79]
    s_waitcnt lgkmcnt(2)
    s_barrier
    ds_read_b128 a[220:223], v4 offset:12608
    s_add_u32 s76, s76, 4096
    buffer_load_dwordx4 a[160:163], v2, s[48:51], s76 offen offset:0 sc1
    v_mfma_f32_32x32x16_bf16 v[128:143], a[84:87], a[204:207], v[128:143]
    s_waitcnt vmcnt(18)
    ds_read_b128 a[192:195], v3 offset:13712
    v_permlane32_swap_b32 v192, v194
    v_permlane32_swap_b32 v193, v195
    v_add_f32 v192, v192, v194
    v_add_f32_e64 v193, v193, v195
    v_mfma_f32_32x32x16_bf16 v[32:47], a[88:91], a[208:211], v[32:47]
    s_waitcnt lgkmcnt(3)
    ds_read_b128 a[196:199], v4 offset:13712
    buffer_load_dwordx4 a[164:167], v2, s[48:51], s76 offen offset:1024 sc1
    v_lshl_add_u32 v204, v204, 2, v205
    v_lshl_add_u32 v204, v204, 2, s11
    v_mfma_f32_32x32x16_bf16 v[96:111], a[88:91], a[212:215], v[96:111]
    s_waitcnt vmcnt(18) lgkmcnt(3)
    ds_read_b128 a[200:203], v3 offset:13696
    v_permlane16_swap_b32 v192, v193
    v_add_f32 v192, v192, v193
    v_lshl_add_u32 v205, v1, 2, s11
    v_mov_b32_e64 v224, 0
    v_add_f32_dpp v192, v192, v192 row_ror:8 row_mask:0xf bank_mask:0xf
    v_mfma_f32_32x32x16_bf16 v[80:95], a[92:95], a[216:219], v[80:95]
    s_waitcnt lgkmcnt(3)
    ds_read_b128 a[204:207], v4 offset:13696
    buffer_load_dwordx4 a[168:171], v2, s[48:51], s76 offen offset:2048 sc1
    v_cvt_pk_bf16_f32 v192, v192, v224
    v_mfma_f32_32x32x16_bf16 v[144:159], a[92:95], a[220:223], v[144:159]
    s_waitcnt vmcnt(18) lgkmcnt(3)
    ds_read_b128 a[208:211], v3 offset:13728
    ds_write_b32 v204, v192 offset:1536
    s_mov_b32 exec_hi, 0
    ds_read_b32 v224, v205 offset:1536
    s_mov_b32 exec_hi, -1
    v_mov_b32 v225, 0
    v_mfma_f32_32x32x16_bf16 v[48:63], a[96:99], a[192:195], v[48:63]
    s_waitcnt vmcnt(17) lgkmcnt(5)
    ds_read_b128 a[212:215], v4 offset:13728
    buffer_load_dwordx4 a[172:175], v2, s[48:51], s76 offen offset:3072 sc1
    v_mov_b32 v229, 0
    v_mov_b32 v226, 0
    v_mov_b32_e64 v230, 0
    v_mfma_f32_32x32x16_bf16 v[48:63], a[100:103], a[196:199], v[48:63]
    s_waitcnt vmcnt(17) lgkmcnt(5)
    ds_read_b128 a[216:219], v3 offset:14256
    v_mov_b32 v227, 0
    v_mov_b32_e64 v231, 0
    v_mov_b32 v228, 0x3f80
    v_and_b32 v20, 1, v1
    v_and_b32_e64 v21, 32, v1
    v_mfma_f32_32x32x16_bf16 v[48:63], a[104:107], a[200:203], v[48:63]
    s_waitcnt vmcnt(16) lgkmcnt(5)
    ds_read_b128 a[220:223], v4 offset:14256
    s_add_u32 s76, s76, 4096
    buffer_load_dwordx4 a[176:179], v2, s[48:51], s76 offen offset:0 sc1
    v_lshl_add_u32 v20, v20, 6, v21
    v_add_u32 v20, s77, v20
    v_mfma_f32_32x32x16_bf16 v[48:63], a[108:111], a[204:207], v[48:63]
    s_waitcnt vmcnt(16) lgkmcnt(5)
    ds_read_b128 a[192:195], v3 offset:14240
    v_mfma_f32_32x32x16_bf16 v[48:63], a[112:115], a[208:211], v[48:63]
    s_waitcnt vmcnt(15) lgkmcnt(3)
    ds_read_b128 a[196:199], v4 offset:14240
    v_mfma_f32_32x32x16_bf16 v[48:63], a[116:119], a[212:215], v[48:63]
    s_waitcnt vmcnt(14) lgkmcnt(3)
    ds_read_b128 a[200:203], v3 offset:14272
    buffer_load_dwordx4 a[180:183], v2, s[48:51], s76 offen offset:1024 sc1
    v_mfma_f32_32x32x16_bf16 v[64:79], a[120:123], a[216:219], v[64:79]
    s_waitcnt vmcnt(14) lgkmcnt(3)
    ds_read_b128 a[204:207], v4 offset:14272
    v_mfma_f32_32x32x16_bf16 v[64:79], a[124:127], a[220:223], v[64:79]
    s_waitcnt vmcnt(13) lgkmcnt(3)
    ds_read_b128 a[208:211], v3 offset:15888
    buffer_load_dwordx4 a[184:187], v2, s[48:51], s76 offen offset:2048 sc1
    v_fmac_f32 v32, 0.5, v48
    v_fmac_f32 v33, 0.5, v49
    v_fmac_f32 v34, 0.5, v50
    v_mfma_f32_32x32x16_bf16 v[64:79], a[128:131], a[192:195], v[64:79]
    s_waitcnt vmcnt(13) lgkmcnt(3)
    ds_read_b128 a[212:215], v4 offset:15888
    v_fmac_f32 v35, 0.5, v51
    v_fmac_f32 v36, 0.5, v52
    v_fmac_f32 v37, 0.5, v53
    v_fmac_f32 v38, 0.5, v54
    v_fmac_f32 v39, 0.5, v55
    v_mfma_f32_32x32x16_bf16 v[64:79], a[132:135], a[196:199], v[64:79]
    s_waitcnt vmcnt(12) lgkmcnt(3)
    ds_read_b128 a[216:219], v3 offset:15872
    buffer_load_dwordx4 a[188:191], v2, s[48:51], s76 offen offset:3072 sc1
    v_fmac_f32 v40, 0.5, v56
    v_fmac_f32 v41, 0.5, v57
    v_fmac_f32 v42, 0.5, v58
    v_mfma_f32_32x32x16_bf16 v[64:79], a[136:139], a[200:203], v[64:79]
    s_waitcnt vmcnt(12) lgkmcnt(3)
    ds_read_b128 a[220:223], v4 offset:15872
    v_fmac_f32 v43, 0.5, v59
    v_fmac_f32 v44, 0.5, v60
    v_fmac_f32 v45, 0.5, v61
    v_fmac_f32 v46, 0.5, v62
    v_fmac_f32_e64 v47, 0.5, v63
    v_mfma_f32_32x32x16_bf16 v[64:79], a[140:143], a[204:207], v[64:79]
    s_waitcnt lgkmcnt(3)
    ds_read_b128 a[192:195], v3 offset:15904
    s_add_u32 s76, s76, 4096
    buffer_load_dwordx4 a[0:3], v2, s[48:51], s76 offen offset:0 sc1
    v_mfma_f32_32x32x16_bf16 v[112:127], a[96:99], a[208:211], v[112:127]
    s_waitcnt lgkmcnt(3)
    ds_read_b128 a[196:199], v4 offset:15904
    v_mfma_f32_32x32x16_bf16 v[112:127], a[100:103], a[212:215], v[112:127]
    s_waitcnt lgkmcnt(3)
    ds_read_b128 a[200:203], v3 offset:16432
    v_fmac_f32 v32, 0.5, v64
    v_fmac_f32 v33, 0.5, v65
    v_fmac_f32 v34, 0.5, v66
    v_fmac_f32 v35, 0.5, v67
    v_fmac_f32 v36, 0.5, v68
    v_mfma_f32_32x32x16_bf16 v[112:127], a[104:107], a[216:219], v[112:127]
    s_waitcnt lgkmcnt(3)
    ds_read_b128 a[204:207], v4 offset:16432
    buffer_load_dwordx4 a[4:7], v2, s[48:51], s76 offen offset:1024 sc1
    v_fmac_f32 v37, 0.5, v69
    v_fmac_f32 v38, 0.5, v70
    v_fmac_f32 v39, 0.5, v71
    v_mfma_f32_32x32x16_bf16 v[112:127], a[108:111], a[220:223], v[112:127]
    s_waitcnt lgkmcnt(3)
    ds_read_b128 a[208:211], v3 offset:16416
    v_fmac_f32 v40, 0.5, v72
    v_fmac_f32 v41, 0.5, v73
    v_fmac_f32 v42, 0.5, v74
    v_fmac_f32 v43, 0.5, v75
    v_fmac_f32_e64 v44, 0.5, v76
    v_mfma_f32_32x32x16_bf16 v[112:127], a[112:115], a[192:195], v[112:127]
    s_waitcnt lgkmcnt(3)
    ds_read_b128 a[212:215], v4 offset:16416
    buffer_load_dwordx4 a[8:11], v2, s[48:51], s76 offen offset:2048 sc1
    v_fmac_f32 v45, 0.5, v77
    v_fmac_f32 v46, 0.5, v78
    v_fmac_f32_e64 v47, 0.5, v79
    v_mfma_f32_32x32x16_bf16 v[112:127], a[116:119], a[196:199], v[112:127]
    s_waitcnt lgkmcnt(3)
    ds_read_b128 a[216:219], v3 offset:16448
    v_mfma_f32_32x32x16_bf16 v[128:143], a[120:123], a[200:203], v[128:143]
    s_waitcnt lgkmcnt(3)
    ds_read_b128 a[220:223], v4 offset:16448
    buffer_load_dwordx4 a[12:15], v2, s[48:51], s76 offen offset:3072 sc1
    v_mfma_f32_32x32x16_bf16 v[128:143], a[124:127], a[204:207], v[128:143]
    s_waitcnt lgkmcnt(3)
    ds_read_b128 a[192:195], v3 offset:13168
    v_fmac_f32 v144, 0.5, v112
    v_fmac_f32 v145, 0.5, v113
    v_fmac_f32 v146, 0.5, v114
    v_fmac_f32 v147, 0.5, v115
    v_fmac_f32 v148, 0.5, v116
    v_fmac_f32_e64 v149, 0.5, v117
    v_mfma_f32_32x32x16_bf16 v[128:143], a[128:131], a[208:211], v[128:143]
    s_waitcnt lgkmcnt(3)
    ds_read_b128 a[196:199], v4 offset:13168
    v_fmac_f32 v150, 0.5, v118
    v_fmac_f32 v151, 0.5, v119
    v_fmac_f32 v152, 0.5, v120
    v_fmac_f32 v153, 0.5, v121
    v_fmac_f32 v154, 0.5, v122
    v_fmac_f32 v155, 0.5, v123
    v_mfma_f32_32x32x16_bf16 v[128:143], a[132:135], a[212:215], v[128:143]
    s_waitcnt lgkmcnt(3)
    ds_read_b128 a[200:203], v3 offset:13152
    v_fmac_f32 v156, 0.5, v124
    v_fmac_f32 v157, 0.5, v125
    v_fmac_f32_e64 v158, 0.5, v126
    v_fmac_f32_e64 v159, 0.5, v127
    v_mfma_f32_32x32x16_bf16 v[128:143], a[136:139], a[216:219], v[128:143]
    s_waitcnt lgkmcnt(3)
    ds_read_b128 a[204:207], v4 offset:13152
    v_mfma_f32_32x32x16_bf16 v[128:143], a[140:143], a[220:223], v[128:143]
    s_waitcnt vmcnt(15) lgkmcnt(3)
    ds_read_b128 a[208:211], v3 offset:13184
    v_mfma_f32_32x32x16_bf16 v[32:47], a[144:147], a[192:195], v[32:47]
    s_waitcnt vmcnt(14) lgkmcnt(3)
    ds_read_b128 a[212:215], v4 offset:13184
    v_mfma_f32_32x32x16_bf16 v[32:47], a[148:151], a[196:199], v[32:47]
    s_waitcnt vmcnt(13) lgkmcnt(3)
    ds_read_b128 a[216:219], v3 offset:16976
    v_fmac_f32 v144, -0.5, v128
    v_fmac_f32 v145, -0.5, v129
    v_fmac_f32 v146, -0.5, v130
    v_fmac_f32 v147, -0.5, v131
    v_fmac_f32 v148, -0.5, v132
    v_fmac_f32 v149, -0.5, v133
    v_fmac_f32 v150, -0.5, v134
    v_mfma_f32_32x32x16_bf16 v[32:47], a[152:155], a[200:203], v[32:47]
    s_waitcnt vmcnt(12) lgkmcnt(3)
    ds_read_b128 a[220:223], v4 offset:16976
    v_fmac_f32 v151, -0.5, v135
    v_fmac_f32 v152, -0.5, v136
    v_fmac_f32 v153, -0.5, v137
    v_fmac_f32 v154, -0.5, v138
    v_fmac_f32 v155, -0.5, v139
    v_fmac_f32 v156, -0.5, v140
    v_fmac_f32 v157, -0.5, v141
    v_mfma_f32_32x32x16_bf16 v[32:47], a[156:159], a[204:207], v[32:47]
    s_waitcnt vmcnt(11) lgkmcnt(3)
    ds_read_b128 a[192:195], v3 offset:16960
    v_fmac_f32 v158, -0.5, v142
    v_fmac_f32 v159, -0.5, v143
    v_mfma_f32_32x32x16_bf16 v[32:47], a[160:163], a[208:211], v[32:47]
    v_mfma_f32_32x32x16_bf16 v[32:47], v[224:227], v[228:231], v[32:47]
    s_waitcnt vmcnt(10) lgkmcnt(3)
    ds_read_b128 a[196:199], v4 offset:16960
    v_fmac_f32 v80, 0.5, v48
    v_fmac_f32 v81, 0.5, v49
    v_fmac_f32 v82, 0.5, v50
    v_fmac_f32 v83, 0.5, v51
    v_fmac_f32 v84, 0.5, v52
    v_fmac_f32 v85, 0.5, v53
    v_fmac_f32 v86, 0.5, v54
    v_mfma_f32_32x32x16_bf16 v[32:47], a[164:167], a[212:215], v[32:47]
    s_waitcnt vmcnt(9) lgkmcnt(3)
    ds_read_b128 a[200:203], v3 offset:16992
    v_fmac_f32 v87, 0.5, v55
    v_fmac_f32 v88, 0.5, v56
    v_fmac_f32 v89, 0.5, v57
    v_fmac_f32 v90, 0.5, v58
    v_fmac_f32 v91, 0.5, v59
    v_fmac_f32 v92, 0.5, v60
    v_fmac_f32 v93, 0.5, v61
    v_mfma_f32_32x32x16_bf16 v[144:159], a[168:171], a[216:219], v[144:159]
    s_waitcnt vmcnt(8) lgkmcnt(3)
    ds_read_b128 a[204:207], v4 offset:16992
    v_fmac_f32 v94, 0.5, v62
    v_fmac_f32 v95, 0.5, v63
    v_fmac_f32 v80, -0.5, v64
    v_fmac_f32 v81, -0.5, v65
    v_fmac_f32 v82, -0.5, v66
    v_fmac_f32 v83, -0.5, v67
    v_fmac_f32 v84, -0.5, v68
    v_mfma_f32_32x32x16_bf16 v[144:159], a[172:175], a[220:223], v[144:159]
    s_waitcnt vmcnt(7) lgkmcnt(3)
    ds_read_b128 a[208:211], v3 offset:14800
    v_fmac_f32 v85, -0.5, v69
    v_fmac_f32 v86, -0.5, v70
    v_fmac_f32 v87, -0.5, v71
    v_fmac_f32 v88, -0.5, v72
    v_fmac_f32 v89, -0.5, v73
    v_fmac_f32 v90, -0.5, v74
    v_fmac_f32 v91, -0.5, v75
    v_mfma_f32_32x32x16_bf16 v[144:159], a[176:179], a[192:195], v[144:159]
    s_waitcnt vmcnt(6) lgkmcnt(3)
    ds_read_b128 a[212:215], v4 offset:14800
    v_fmac_f32 v92, -0.5, v76
    v_fmac_f32 v93, -0.5, v77
    v_fmac_f32 v94, -0.5, v78
    v_fmac_f32_e64 v95, -0.5, v79
    v_mfma_f32_32x32x16_bf16 v[144:159], a[180:183], a[196:199], v[144:159]
    s_waitcnt vmcnt(5) lgkmcnt(3)
    ds_read_b128 a[216:219], v3 offset:14784
    v_cvt_pk_bf16_f32 v160, v32, v33
    v_cvt_pk_bf16_f32 v161, v34, v35
    v_cvt_pk_bf16_f32 v162, v36, v37
    v_cvt_pk_bf16_f32 v163, v38, v39
    v_cvt_pk_bf16_f32 v164, v40, v41
    v_cvt_pk_bf16_f32 v165, v42, v43
    v_cvt_pk_bf16_f32 v166, v44, v45
    v_cvt_pk_bf16_f32 v167, v46, v47
    v_mfma_f32_32x32x16_bf16 v[144:159], a[184:187], a[200:203], v[144:159]
    v_mfma_f32_32x32x16_bf16 v[144:159], v[224:227], v[228:231], v[144:159]
    s_waitcnt vmcnt(4) lgkmcnt(3)
    ds_read_b128 a[220:223], v4 offset:14784
    buffer_store_dwordx4 v[160:163], v6, s[48:51], s68 offen offset:0 sc1
    v_mfma_f32_32x32x16_bf16 v[144:159], a[188:191], a[204:207], v[144:159]
    s_waitcnt lgkmcnt(3)
    ds_read_b128 a[192:195], v3 offset:14816
    buffer_store_dwordx4 v[164:167], v6, s[48:51], s70 offen offset:0 sc1
    v_mfma_f32_32x32x16_bf16 v[80:95], a[168:171], a[208:211], v[80:95]
    s_waitcnt lgkmcnt(3)
    ds_read_b128 a[196:199], v4 offset:14816
    s_mov_b32 exec_lo, 0x80000001
    s_mov_b32 exec_hi, 0x80000001
    ds_write_b128 v20, v[160:163] offset:17536
    ds_write_b128 v20, v[164:167] offset:17552
    s_mov_b64 exec, -1
    v_mfma_f32_32x32x16_bf16 v[80:95], a[172:175], a[212:215], v[80:95]
    s_waitcnt lgkmcnt(5)
    ds_read_b128 a[200:203], v3 offset:15344
    v_fmac_f32 v96, 0.5, v112
    v_fmac_f32 v97, 0.5, v113
    v_fmac_f32 v98, 0.5, v114
    v_fmac_f32 v99, 0.5, v115
    v_fmac_f32 v100, 0.5, v116
    v_fmac_f32 v101, 0.5, v117
    v_fmac_f32 v102, 0.5, v118
    v_fmac_f32 v103, 0.5, v119
    v_mfma_f32_32x32x16_bf16 v[80:95], a[176:179], a[216:219], v[80:95]
    s_waitcnt lgkmcnt(5)
    ds_read_b128 a[204:207], v4 offset:15344
    v_fmac_f32 v104, 0.5, v120
    v_fmac_f32 v105, 0.5, v121
    v_fmac_f32 v106, 0.5, v122
    v_fmac_f32 v107, 0.5, v123
    v_fmac_f32 v108, 0.5, v124
    v_fmac_f32 v109, 0.5, v125
    v_fmac_f32 v110, 0.5, v126
    v_fmac_f32 v111, 0.5, v127
    v_mfma_f32_32x32x16_bf16 v[80:95], a[180:183], a[220:223], v[80:95]
L_hop3:
    s_cbranch_execz L_hop_ret
    s_waitcnt lgkmcnt(5)
    ds_read_b128 a[208:211], v3 offset:15328
    v_fmac_f32 v96, 0.5, v128
    v_fmac_f32 v97, 0.5, v129
    v_fmac_f32 v98, 0.5, v130
    v_fmac_f32 v99, 0.5, v131
    v_fmac_f32 v100, 0.5, v132
    v_fmac_f32 v101, 0.5, v133
    v_fmac_f32 v102, 0.5, v134
    v_fmac_f32 v103, 0.5, v135
    v_mfma_f32_32x32x16_bf16 v[80:95], a[184:187], a[192:195], v[80:95]
    v_mfma_f32_32x32x16_bf16 v[80:95], v[224:227], v[228:231], v[80:95]
    s_waitcnt lgkmcnt(5)
    ds_read_b128 a[212:215], v4 offset:15328
    v_fmac_f32 v104, 0.5, v136
    v_fmac_f32 v105, 0.5, v137
    v_fmac_f32 v106, 0.5, v138
    v_fmac_f32 v107, 0.5, v139
    v_fmac_f32 v108, 0.5, v140
    v_fmac_f32 v109, 0.5, v141
    v_fmac_f32 v110, 0.5, v142
    v_fmac_f32_e64 v111, 0.5, v143
    v_mfma_f32_32x32x16_bf16 v[80:95], a[188:191], a[196:199], v[80:95]
    s_waitcnt lgkmcnt(3)
    ds_read_b128 a[216:219], v3 offset:15360
    v_cvt_pk_bf16_f32 v184, v144, v145
    v_cvt_pk_bf16_f32 v185, v146, v147
    v_cvt_pk_bf16_f32 v186, v148, v149
    v_cvt_pk_bf16_f32 v187, v150, v151
    v_cvt_pk_bf16_f32 v188, v152, v153
    v_cvt_pk_bf16_f32 v189, v154, v155
    v_mfma_f32_32x32x16_bf16 v[96:111], a[144:147], a[200:203], v[96:111]
    s_waitcnt lgkmcnt(3)
    ds_read_b128 a[220:223], v4 offset:15360
    v_cvt_pk_bf16_f32 v190, v156, v157
    v_cvt_pk_bf16_f32 v191, v158, v159
    v_mfma_f32_32x32x16_bf16 v[96:111], a[148:151], a[204:207], v[96:111]
    s_waitcnt lgkmcnt(3)
    buffer_store_dwordx4 v[184:187], v6, s[48:51], s69 offen offset:2048 sc1
    v_mfma_f32_32x32x16_bf16 v[96:111], a[152:155], a[208:211], v[96:111]
    s_waitcnt lgkmcnt(2)
    buffer_store_dwordx4 v[188:191], v6, s[48:51], s71 offen offset:2048 sc1
    v_mfma_f32_32x32x16_bf16 v[96:111], a[156:159], a[212:215], v[96:111]
    s_waitcnt lgkmcnt(1)
    s_mov_b32 exec_lo, 0x80000001
    s_mov_b32 exec_hi, 0x80000001
    ds_write_b128 v20, v[184:187] offset:17920
    ds_write_b128 v20, v[188:191] offset:17936
    s_mov_b64 exec, -1
    v_mfma_f32_32x32x16_bf16 v[96:111], a[160:163], a[216:219], v[96:111]
    v_mfma_f32_32x32x16_bf16 v[96:111], v[224:227], v[228:231], v[96:111]
    s_waitcnt lgkmcnt(2)
    v_cvt_pk_bf16_f32 v168, v80, v81
    v_cvt_pk_bf16_f32 v169, v82, v83
    v_cvt_pk_bf16_f32 v170, v84, v85
    v_cvt_pk_bf16_f32 v171, v86, v87
    v_cvt_pk_bf16_f32 v172, v88, v89
    v_cvt_pk_bf16_f32 v173, v90, v91
    v_cvt_pk_bf16_f32 v174, v92, v93
    v_cvt_pk_bf16_f32 v175, v94, v95
    v_mfma_f32_32x32x16_bf16 v[96:111], a[164:167], a[220:223], v[96:111]
    s_mov_b32 exec_lo, 0x80000001
    s_mov_b32 exec_hi, 0x80000001
    ds_write_b128 v20, v[168:171] offset:17664
    ds_write_b128 v20, v[172:175] offset:17680
    s_mov_b64 exec, -1
    s_nop 11
    v_cvt_pk_bf16_f32 v176, v96, v97
    v_cvt_pk_bf16_f32 v177, v98, v99
    v_cvt_pk_bf16_f32 v178, v100, v101
    v_cvt_pk_bf16_f32 v179, v102, v103
    v_cvt_pk_bf16_f32 v180, v104, v105
    v_cvt_pk_bf16_f32 v181, v106, v107
    v_cvt_pk_bf16_f32 v182, v108, v109
    v_cvt_pk_bf16_f32 v183, v110, v111
    s_mov_b32 exec_lo, 0x80000001
    s_mov_b32 exec_hi, 0x80000001
    ds_write_b128 v20, v[176:179] offset:17792
    ds_write_b128 v20, v[180:183] offset:17808
    s_mov_b64 exec, -1
    ds_read_u16 v192, v9 offset:0
    ds_read_u16 v193, v9 offset:128
    ds_read_u16 v194, v9 offset:256
    ds_read_u16 v195, v9 offset:384
    v_mov_b32 v197, s9
    v_mov_b32_e64 v199, s9
    s_add_u32 s0, s0, 0x900000
    s_add_u32 s24, s24, 0x900000
    s_add_u32 s25, s25, 0x900000
    v_dot2c_f32_bf16 v22, s62, v160
    v_dot2c_f32_bf16 v23, v160, v160
    v_dot2c_f32_bf16 v22, s62, v161
    v_dot2c_f32_bf16 v23, v161, v161
    v_dot2c_f32_bf16 v22, s62, v162
    v_dot2c_f32_bf16 v23, v162, v162
    v_dot2c_f32_bf16 v22, s62, v163
    v_dot2c_f32_bf16 v23, v163, v163
    v_dot2c_f32_bf16 v22, s62, v164
    v_dot2c_f32_bf16 v23, v164, v164
    v_dot2c_f32_bf16 v22, s62, v165
    v_dot2c_f32_bf16 v23, v165, v165
    v_dot2c_f32_bf16 v22, s62, v166
    v_dot2c_f32_bf16 v23, v166, v166
    v_dot2c_f32_bf16 v22, s62, v167
    v_dot2c_f32_bf16 v23, v167, v167
    v_dot2c_f32_bf16 v22, s62, v168
    v_dot2c_f32_bf16 v23, v168, v168
    v_dot2c_f32_bf16 v22, s62, v169
    v_dot2c_f32_bf16 v23, v169, v169
    v_dot2c_f32_bf16 v22, s62, v170
    v_dot2c_f32_bf16 v23, v170, v170
    v_dot2c_f32_bf16 v22, s62, v171
    v_dot2c_f32_bf16 v23, v171, v171
    v_dot2c_f32_bf16 v22, s62, v172
    v_dot2c_f32_bf16 v23, v172, v172
    v_dot2c_f32_bf16 v22, s62, v173
    v_dot2c_f32_bf16 v23, v173, v173
    v_dot2c_f32_bf16 v22, s62, v174
    v_dot2c_f32_bf16 v23, v174, v174
    v_dot2c_f32_bf16 v22, s62, v175
    v_dot2c_f32_bf16 v23, v175, v175
    v_dot2c_f32_bf16 v22, s62, v176
    v_dot2c_f32_bf16 v23, v176, v176
    v_dot2c_f32_bf16 v22, s62, v177
    v_dot2c_f32_bf16 v23, v177, v177
    v_dot2c_f32_bf16 v22, s62, v178
    v_dot2c_f32_bf16 v23, v178, v178
    v_dot2c_f32_bf16 v22, s62, v179
    v_dot2c_f32_bf16 v23, v179, v179
    v_dot2c_f32_bf16 v22, s62, v180
    v_dot2c_f32_bf16 v23, v180, v180
    v_dot2c_f32_bf16 v22, s62, v181
    v_dot2c_f32_bf16 v23, v181, v181
    v_dot2c_f32_bf16 v22, s62, v182
    v_dot2c_f32_bf16 v23, v182, v182
    v_dot2c_f32_bf16 v22, s62, v183
    v_dot2c_f32_bf16 v23, v183, v183
    v_dot2c_f32_bf16 v22, s62, v184
    v_dot2c_f32_bf16 v23, v184, v184
    v_dot2c_f32_bf16 v22, s62, v185
    v_dot2c_f32_bf16 v23, v185, v185
    v_dot2c_f32_bf16 v22, s62, v186
    v_dot2c_f32_bf16 v23, v186, v186
    v_dot2c_f32_bf16 v22, s62, v187
    v_dot2c_f32_bf16 v23, v187, v187
    v_dot2c_f32_bf16 v22, s62, v188
    v_dot2c_f32_bf16 v23, v188, v188
    v_dot2c_f32_bf16 v22, s62, v189
    v_dot2c_f32_bf16 v23, v189, v189
    v_dot2c_f32_bf16 v22, s62, v190
    v_dot2c_f32_bf16 v23, v190, v190
    v_dot2c_f32_bf16 v22, s62, v191
    v_dot2c_f32_bf16 v23, v191, v191
    s_waitcnt lgkmcnt(0)
    v_lshl_or_b32 v196, v193, 16, v192
    v_lshl_or_b32 v198, v195, 16, v194
    buffer_store_dwordx4 v[196:199], v2, s[48:51], s0 offen offset:512 sc1
    s_nop 2
    s_nop 1
    v_add_f32_dpp v22, v22, v22 row_shr:1 row_mask:0xf bank_mask:0xf bound_ctrl:0
    v_add_f32_dpp v23, v23, v23 row_shr:1 row_mask:0xf bank_mask:0xf bound_ctrl:0
    s_nop 0
    v_add_f32_dpp v22, v22, v22 row_shr:2 row_mask:0xf bank_mask:0xf bound_ctrl:0
    v_add_f32_dpp v23, v23, v23 row_shr:2 row_mask:0xf bank_mask:0xf bound_ctrl:0
    s_nop 0
    v_add_f32_dpp v22, v22, v22 row_shr:4 row_mask:0xf bank_mask:0xf bound_ctrl:0
    v_add_f32_dpp v23, v23, v23 row_shr:4 row_mask:0xf bank_mask:0xf bound_ctrl:0
    s_nop 0
    v_add_f32_dpp v22, v22, v22 row_shr:8 row_mask:0xf bank_mask:0xf bound_ctrl:0
    v_add_f32_dpp v23, v23, v23 row_shr:8 row_mask:0xf bank_mask:0xf bound_ctrl:0
    s_nop 0
    v_add_f32_dpp v22, v22, v22 row_bcast:15 row_mask:0xa bank_mask:0xf
    v_add_f32_dpp v23, v23, v23 row_bcast:15 row_mask:0xa bank_mask:0xf
    s_nop 0
    v_add_f32_dpp v22, v22, v22 row_bcast:31 row_mask:0xc bank_mask:0xf
    v_add_f32_dpp v23, v23, v23 row_bcast:31 row_mask:0xc bank_mask:0xf
    s_nop 0
    s_lshl_b32 s10, s3, 3
    v_mov_b32 v24, s10
    s_mov_b32 exec_lo, 0x0
    s_mov_b32 exec_hi, 0x80000000
    ds_write_b64 v24, v[22:23] offset:2048
    s_mov_b64 exec, -1
    s_lshl_b32 s12, s4, 9
    s_add_u32 s13, s12, s7
    s_lshl_b32 s13, s13, 6
    s_add_u32 s13, s13, 0x50000
    v_and_b32 v24, 3, v1
    v_lshrrev_b32 v30, 2, v1
    v_lshlrev_b32_e64 v30, 13, v30
    v_lshl_add_u32 v30, v24, 4, v30
    v_lshlrev_b32 v24, 3, v24
    v_mov_b32_e64 v49, s9
    v_mov_b32_e64 v51, s9
    s_cmp_lg_u32 s3, 0
    s_waitcnt lgkmcnt(0)
    s_waitcnt vmcnt(1)
    s_barrier
    s_cbranch_scc1 L_pub2_done
    s_mov_b64 exec, 0xffff
    ds_read_b32 v48, v24 offset:2048
    ds_read_b32 v50, v24 offset:2052
    s_waitcnt lgkmcnt(0)
    buffer_store_dwordx4 v[48:51], v30, s[48:51], s13 offen sc1
    s_mov_b64 exec, -1
L_pub2_done:
    s_lshl_b32 s13, s3, 5
    s_add_u32 s12, s12, s13
    s_lshr_b32 s13, s7, 5
    s_lshl_b32 s13, s13, 7
    s_add_u32 s12, s12, s13
    s_lshl_b32 s12, s12, 6
    s_add_u32 s1, s12, 0x50000
    ds_read_b128 v[240:243], v28 offset:1280
    ds_read_b128 v[244:247], v28 offset:1312
    v_accvgpr_read_b32 v216, a224
    v_accvgpr_read_b32 v217, a225
    v_accvgpr_read_b32 v218, a226
    v_accvgpr_read_b32 v219, a227
    v_accvgpr_read_b32 v220, a228
    v_accvgpr_read_b32 v221, a229
    v_accvgpr_read_b32 v222, a230
    v_accvgpr_read_b32 v223, a231
    v_lshlrev_b32 v32, 16, v216
    v_and_b32 v33, s78, v216
    v_lshlrev_b32 v34, 16, v217
    v_and_b32 v35, s78, v217
    v_lshlrev_b32 v36, 16, v218
    v_and_b32 v37, s78, v218
    v_lshlrev_b32 v38, 16, v219
    v_and_b32 v39, s78, v219
    v_lshlrev_b32 v40, 16, v220
    v_and_b32 v41, s78, v220
    v_lshlrev_b32 v42, 16, v221
    v_and_b32 v43, s78, v221
    v_lshlrev_b32 v44, 16, v222
    v_and_b32 v45, s78, v222
    v_lshlrev_b32 v46, 16, v223
    v_and_b32 v47, s78, v223
    v_accvgpr_read_b32 v216, a232
    v_accvgpr_read_b32 v217, a233
    v_accvgpr_read_b32 v218, a234
    v_accvgpr_read_b32 v219, a235
    v_accvgpr_read_b32 v220, a236
    v_accvgpr_read_b32 v221, a237
    v_accvgpr_read_b32 v222, a238
    v_accvgpr_read_b32 v223, a239
    v_lshlrev_b32 v80, 16, v216
    v_and_b32 v81, s78, v216
    v_lshlrev_b32 v82, 16, v217
    v_and_b32 v83, s78, v217
    s_add_u32 s76, s76, 4096
    buffer_load_dwordx4 a[16:19], v2, s[48:51], s76 offen offset:0 sc1
    v_lshlrev_b32 v84, 16, v218
    v_and_b32 v85, s78, v218
    v_lshlrev_b32 v86, 16, v219
    v_and_b32 v87, s78, v219
    buffer_load_dwordx4 a[20:23], v2, s[48:51], s76 offen offset:1024 sc1
    v_lshlrev_b32 v88, 16, v220
    v_and_b32 v89, s78, v220
    v_lshlrev_b32 v90, 16, v221
    v_and_b32 v91, s78, v221
    buffer_load_dwordx4 a[24:27], v2, s[48:51], s76 offen offset:2048 sc1
    v_lshlrev_b32 v92, 16, v222
    v_and_b32 v93, s78, v222
    v_lshlrev_b32 v94, 16, v223
    v_and_b32 v95, s78, v223
    buffer_load_dwordx4 a[28:31], v2, s[48:51], s76 offen offset:3072 sc1
    v_accvgpr_read_b32 v216, a240
    v_accvgpr_read_b32 v217, a241
    v_accvgpr_read_b32 v218, a242
    v_accvgpr_read_b32 v219, a243
    v_accvgpr_read_b32 v220, a244
    v_accvgpr_read_b32 v221, a245
    v_accvgpr_read_b32 v222, a246
    v_accvgpr_read_b32 v223, a247
    v_lshlrev_b32 v96, 16, v216
    v_and_b32 v97, s78, v216
    v_lshlrev_b32 v98, 16, v217
    v_and_b32 v99, s78, v217
    s_add_u32 s76, s76, 4096
    buffer_load_dwordx4 a[32:35], v2, s[48:51], s76 offen offset:0 sc1
    v_lshlrev_b32 v100, 16, v218
    v_and_b32 v101, s78, v218
    v_lshlrev_b32 v102, 16, v219
    v_and_b32 v103, s78, v219
    buffer_load_dwordx4 a[36:39], v2, s[48:51], s76 offen offset:1024 sc1
    v_lshlrev_b32 v104, 16, v220
    v_and_b32 v105, s78, v220
    v_lshlrev_b32 v106, 16, v221
    v_and_b32 v107, s78, v221
    buffer_load_dwordx4 a[40:43], v2, s[48:51], s76 offen offset:2048 sc1
    v_lshlrev_b32 v108, 16, v222
    v_and_b32 v109, s78, v222
    v_lshlrev_b32 v110, 16, v223
    v_and_b32 v111, s78, v223
    buffer_load_dwordx4 a[44:47], v2, s[48:51], s76 offen offset:3072 sc1
    v_accvgpr_read_b32 v216, a248
    v_accvgpr_read_b32 v217, a249
    v_accvgpr_read_b32 v218, a250
    v_accvgpr_read_b32 v219, a251
    v_accvgpr_read_b32 v220, a252
    v_accvgpr_read_b32 v221, a253
    v_accvgpr_read_b32 v222, a254
    v_accvgpr_read_b32 v223, a255
    v_lshlrev_b32 v144, 16, v216
    v_and_b32 v145, s78, v216
    v_lshlrev_b32 v146, 16, v217
    v_and_b32 v147, s78, v217
    s_add_u32 s76, s76, 4096
    buffer_load_dwordx4 a[48:51], v2, s[48:51], s76 offen offset:0 sc1
    v_lshlrev_b32 v148, 16, v218
    v_and_b32 v149, s78, v218
    v_lshlrev_b32 v150, 16, v219
    v_and_b32 v151, s78, v219
    buffer_load_dwordx4 a[52:55], v2, s[48:51], s76 offen offset:1024 sc1
    v_lshlrev_b32 v152, 16, v220
    v_and_b32 v153, s78, v220
    v_lshlrev_b32 v154, 16, v221
    v_and_b32 v155, s78, v221
    v_lshlrev_b32 v156, 16, v222
    v_and_b32 v157, s78, v222
    v_lshlrev_b32 v158, 16, v223
    v_and_b32 v159, s78, v223
    buffer_load_dwordx4 v[52:55], v2, s[48:51], s1 offen sc1
    buffer_load_dwordx4 v[56:59], v2, s[48:51], s1 offen offset:1024 sc1
    v_lshlrev_b32 v196, 16, v160
    v_and_b32 v197, s78, v160
    v_lshlrev_b32 v198, 16, v161
    v_and_b32 v199, s78, v161
    v_lshlrev_b32 v200, 16, v168
    v_and_b32 v201, s78, v168
    v_lshlrev_b32 v202, 16, v169
    v_and_b32 v203, s78, v169
    v_lshlrev_b32 v204, 16, v176
    v_and_b32 v205, s78, v176
    v_lshlrev_b32 v206, 16, v177
    v_and_b32 v207, s78, v177
    v_lshlrev_b32 v208, 16, v184
    v_and_b32 v209, s78, v184
    v_lshlrev_b32 v210, 16, v185
    v_and_b32 v211, s78, v185
    buffer_load_dwordx4 a[56:59], v2, s[48:51], s76 offen offset:2048 sc1
    buffer_load_dwordx4 a[60:63], v2, s[48:51], s76 offen offset:3072 sc1
    s_add_u32 s76, s76, 4096
    buffer_load_dwordx4 a[64:67], v2, s[48:51], s76 offen offset:0 sc1
    buffer_load_dwordx4 a[68:71], v2, s[48:51], s76 offen offset:1024 sc1
    buffer_load_dwordx4 a[72:75], v2, s[48:51], s76 offen offset:2048 sc1
    buffer_load_dwordx4 a[76:79], v2, s[48:51], s76 offen offset:3072 sc1
    s_add_u32 s76, s76, 4096
    buffer_load_dwordx4 a[80:83], v2, s[48:51], s76 offen offset:0 sc1
    buffer_load_dwordx4 a[84:87], v2, s[48:51], s76 offen offset:1024 sc1
    s_mov_b32 s67, 0
    s_waitcnt vmcnt(8)
L_poll2:
    v_xor_b32 v60, s9, v53
    v_xor_b32 v61, s9, v55
    v_xor_b32 v62, s9, v57
    v_xor_b32 v63, s9, v59
    v_or3_b32 v60, v60, v61, v62
    v_or_b32 v60, v60, v63
    v_cmp_ne_u32 vcc, 0, v60
    s_cbranch_vccz L_poll2_done
    s_add_u32 s67, s67, 1
    s_cmp_ge_u32 s67, 200000
    s_cbranch_scc1 L_poll2_done
    s_sleep 1
    buffer_load_dwordx4 v[52:55], v2, s[48:51], s1 offen sc1
    buffer_load_dwordx4 v[56:59], v2, s[48:51], s1 offen offset:1024 sc1
    s_waitcnt vmcnt(0)
    s_branch L_poll2
L_poll2_done:
    v_add_f32 v52, v52, v56
    v_add_f32 v54, v54, v58
    v_and_b32 v53, 3, v1
    v_lshrrev_b32 v55, 5, v1
    v_permlane32_swap_b32 v52, v54
    v_lshlrev_b32 v53, 5, v53
    v_add_f32_e64 v52, v52, v54
    v_lshl_add_u32 v53, v55, 4, v53
    v_mov_b32 v54, v52
    s_lshl_b32 s10, s3, 2
    v_add_u32 v53, s10, v53
    v_permlane16_swap_b32 v52, v54
    s_lshl_b32 s10, s3, 5
    v_add_f32 v52, v52, v54
    v_mov_b32_e64 v24, s10
    s_nop 0
    v_add_f32_dpp v52, v52, v52 row_shr:4 row_mask:0xf bank_mask:0xf bound_ctrl:0
    s_nop 1
    v_add_f32_dpp v52, v52, v52 row_shr:8 row_mask:0xf bank_mask:0xf bound_ctrl:0
    s_mov_b32 exec_lo, 0xf000
    s_mov_b32 exec_hi, 0xf000
    ds_write_b32 v53, v52 offset:2112
    s_mov_b64 exec, -1
    s_waitcnt lgkmcnt(0)
    s_barrier
    ds_read_b128 v[52:55], v24 offset:2112
    ds_read_b128 v[56:59], v24 offset:2128
    buffer_load_dwordx4 v[224:227], v6, s[48:51], s72 offen sc1
    buffer_load_dwordx4 v[232:235], v6, s[48:51], s74 offen sc1
    s_waitcnt lgkmcnt(0)
    v_pk_add_f32 v[52:53], v[52:53], v[54:55]
    v_pk_add_f32 v[56:57], v[56:57], v[58:59]
    v_add_f32_e64 v22, v52, v53
    v_add_f32 v30, v56, v57
    v_mul_f32 v22, 0xb6000000, v22
    v_mul_f32 v30, 0x36000000, v30
    v_fma_f32 v30, -v22, v22, v30
    v_max_f32 v30, 0, v30
    v_add_f32 v30, 0x3727c5ac, v30
    v_rsq_f32 v30, v30
    buffer_load_dwordx4 v[128:131], v10, s[48:51], s0 offen sc1
    v_mov_b32 v23, v22
    v_mov_b32_e64 v31, v30
    v_pk_mul_f32 v[240:241], v[240:241], v[30:31]
    v_pk_mul_f32 v[242:243], v[242:243], v[30:31]
    v_pk_fma_f32 v[244:245], v[240:241], v[22:23], v[244:245]
    v_pk_fma_f32 v[246:247], v[242:243], v[22:23], v[246:247]
    v_pk_fma_f32 v[200:201], v[200:201], v[240:241], v[244:245]
    v_pk_fma_f32 v[202:203], v[202:203], v[242:243], v[246:247]
    v_pk_fma_f32 v[204:205], v[204:205], v[240:241], v[244:245]
    v_pk_fma_f32 v[206:207], v[206:207], v[242:243], v[246:247]
    v_exp_f32 v216, v200
    v_exp_f32 v217, v201
    v_exp_f32 v218, v202
    v_exp_f32 v219, v203
    v_exp_f32 v220, v204
    v_exp_f32 v221, v205
    v_exp_f32 v222, v206
    v_exp_f32 v223, v207
    buffer_load_dwordx2 v[132:133], v10, s[48:51], s24 offen offset:8 sc1
    v_mul_f32_e64 v25, v30, v15
    v_fma_f32 v26, v22, v25, v16
    v_pk_fma_f32 v[216:217], v[216:217], s[64:65], s[64:65]
    v_pk_fma_f32 v[218:219], v[218:219], s[64:65], s[64:65]
    v_pk_fma_f32 v[220:221], v[220:221], s[64:65], s[64:65]
    v_pk_fma_f32 v[222:223], v[222:223], s[64:65], s[64:65]
    v_rcp_f32 v216, v216
    v_rcp_f32 v217, v217
    v_rcp_f32 v218, v218
    v_rcp_f32 v219, v219
    v_rcp_f32 v220, v220
    v_rcp_f32 v221, v221
    v_rcp_f32 v222, v222
    v_rcp_f32 v223, v223
    buffer_load_dwordx2 v[134:135], v10, s[48:51], s25 offen sc1
    ds_write2_b32 v12, v25, v26 offset0:0 offset1:8
    v_pk_mul_f32 v[200:201], v[200:201], v[216:217]
    v_pk_mul_f32 v[202:203], v[202:203], v[218:219]
    v_pk_mul_f32 v[204:205], v[204:205], v[220:221]
    v_pk_mul_f32 v[206:207], v[206:207], v[222:223]
    v_pk_fma_f32 v[196:197], v[196:197], v[240:241], v[244:245]
    v_pk_fma_f32 v[198:199], v[198:199], v[242:243], v[246:247]
    v_pk_fma_f32 v[208:209], v[208:209], v[240:241], v[244:245]
    v_pk_fma_f32 v[210:211], v[210:211], v[242:243], v[246:247]
    v_exp_f32 v216, v196
    v_exp_f32 v217, v197
    v_exp_f32 v218, v198
    v_exp_f32 v219, v199
    v_exp_f32 v220, v208
    v_exp_f32 v221, v209
    v_exp_f32 v222, v210
    v_exp_f32 v223, v211
    buffer_load_dwordx4 a[88:91], v2, s[48:51], s76 offen offset:2048 sc1
    v_pk_fma_f32 v[216:217], v[216:217], s[64:65], s[64:65]
    v_pk_fma_f32 v[218:219], v[218:219], s[64:65], s[64:65]
    v_pk_fma_f32 v[220:221], v[220:221], s[64:65], s[64:65]
    v_pk_fma_f32 v[222:223], v[222:223], s[64:65], s[64:65]
    v_rcp_f32 v216, v216
    v_rcp_f32 v217, v217
    v_rcp_f32 v218, v218
    v_rcp_f32 v219, v219
    v_rcp_f32 v220, v220
    v_rcp_f32 v221, v221
    v_rcp_f32 v222, v222
    v_rcp_f32 v223, v223
    buffer_load_dwordx4 a[92:95], v2, s[48:51], s76 offen offset:3072 sc1
    v_pk_fma_f32 v[64:65], v[196:197], v[216:217], v[200:201] neg_lo:[0,0,0] neg_hi:[0,0,0]
    v_pk_fma_f32 v[66:67], v[198:199], v[218:219], v[202:203] neg_lo:[0,0,0] neg_hi:[0,0,0]
    v_cvt_pk_bf16_f32 v64, v64, v65
    v_cvt_pk_bf16_f32 v65, v66, v67
    v_pk_fma_f32 v[68:69], v[196:197], v[216:217], v[200:201] neg_lo:[1,0,0] neg_hi:[1,0,0]
    v_pk_fma_f32 v[70:71], v[198:199], v[218:219], v[202:203] neg_lo:[1,0,0] neg_hi:[1,0,0]
    v_cvt_pk_bf16_f32 v68, v68, v69
    v_cvt_pk_bf16_f32 v69, v70, v71
    ds_write_b64 v7, v[64:65] offset:544
    ds_write_b64 v7, v[68:69] offset:1088
    s_add_u32 s76, s76, 4096
    buffer_load_dwordx4 a[96:99], v2, s[48:51], s76 offen offset:0 sc1
    v_pk_fma_f32 v[72:73], v[196:197], v[216:217], v[204:205] neg_lo:[1,0,0] neg_hi:[1,0,0]
    v_pk_fma_f32 v[74:75], v[198:199], v[218:219], v[206:207] neg_lo:[1,0,0] neg_hi:[1,0,0]
    v_cvt_pk_bf16_f32 v72, v72, v73
    v_cvt_pk_bf16_f32 v73, v74, v75
    v_pk_fma_f32 v[76:77], v[208:209], v[220:221], v[200:201] neg_lo:[1,0,0] neg_hi:[1,0,0]
    v_pk_fma_f32 v[78:79], v[210:211], v[222:223], v[202:203] neg_lo:[1,0,0] neg_hi:[1,0,0]
    v_cvt_pk_bf16_f32 v76, v76, v77
    v_cvt_pk_bf16_f32 v77, v78, v79
    ds_write_b64 v7, v[72:73] offset:1632
    ds_write_b64 v7, v[76:77] offset:2176
    buffer_load_dwordx4 a[100:103], v2, s[48:51], s76 offen offset:1024 sc1
    v_pk_fma_f32 v[112:113], v[208:209], v[220:221], v[204:205] neg_lo:[0,0,0] neg_hi:[0,0,0]
    v_pk_fma_f32 v[114:115], v[210:211], v[222:223], v[206:207] neg_lo:[0,0,0] neg_hi:[0,0,0]
    v_cvt_pk_bf16_f32 v112, v112, v113
    v_cvt_pk_bf16_f32 v113, v114, v115
    v_pk_fma_f32 v[116:117], v[208:209], v[220:221], v[204:205] neg_lo:[0,0,1] neg_hi:[0,0,1]
    v_pk_fma_f32 v[118:119], v[210:211], v[222:223], v[206:207] neg_lo:[0,0,1] neg_hi:[0,0,1]
    v_cvt_pk_bf16_f32 v116, v116, v117
    v_cvt_pk_bf16_f32 v117, v118, v119
    ds_write_b64 v7, v[112:113] offset:2720
    ds_write_b64 v7, v[116:117] offset:3264
    buffer_load_dwordx4 a[104:107], v2, s[48:51], s76 offen offset:2048 sc1
    s_waitcnt vmcnt(8)
    v_lshlrev_b32 v192, 16, v224
    v_and_b32 v193, s78, v224
    v_lshlrev_b32 v194, 16, v225
    v_and_b32 v195, s78, v225
    v_lshlrev_b32 v212, 16, v232
    v_and_b32 v213, s78, v232
    v_lshlrev_b32 v214, 16, v233
    v_and_b32_e64 v215, s78, v233
    v_pk_fma_f32 v[192:193], v[192:193], v[240:241], v[244:245]
    v_pk_fma_f32 v[194:195], v[194:195], v[242:243], v[246:247]
    v_pk_fma_f32 v[212:213], v[212:213], v[240:241], v[244:245]
    v_pk_fma_f32 v[214:215], v[214:215], v[242:243], v[246:247]
    v_exp_f32 v216, v192
    v_exp_f32 v217, v193
    v_exp_f32 v218, v194
    v_exp_f32 v219, v195
    v_exp_f32 v220, v212
    v_exp_f32 v221, v213
    v_exp_f32 v222, v214
    v_exp_f32 v223, v215
    buffer_load_dwordx4 a[108:111], v2, s[48:51], s76 offen offset:3072 sc1
    v_pk_fma_f32 v[216:217], v[216:217], s[64:65], v[254:255] op_sel:[0,0,0] op_sel_hi:[1,1,0]
    v_pk_fma_f32 v[218:219], v[218:219], s[64:65], v[254:255] op_sel:[0,0,0] op_sel_hi:[1,1,0]
    v_pk_fma_f32 v[220:221], v[220:221], s[64:65], v[254:255] op_sel:[0,0,1] op_sel_hi:[1,1,1]
    v_pk_fma_f32 v[222:223], v[222:223], s[64:65], v[254:255] op_sel:[0,0,1] op_sel_hi:[1,1,1]
    v_rcp_f32 v216, v216
    v_rcp_f32 v217, v217
    v_rcp_f32 v218, v218
    v_rcp_f32 v219, v219
    v_rcp_f32 v220, v220
    v_rcp_f32 v221, v221
    v_rcp_f32 v222, v222
    v_rcp_f32 v223, v223
    v_pk_fma_f32 v[120:121], v[192:193], v[216:217], v[200:201] neg_lo:[0,0,1] neg_hi:[0,0,1]
    v_pk_fma_f32 v[122:123], v[194:195], v[218:219], v[202:203] neg_lo:[0,0,1] neg_hi:[0,0,1]
    v_cvt_pk_bf16_f32 v120, v120, v121
    v_cvt_pk_bf16_f32 v121, v122, v123
    v_pk_fma_f32 v[124:125], v[212:213], v[220:221], v[204:205] neg_lo:[0,0,1] neg_hi:[0,0,1]
    v_pk_fma_f32 v[126:127], v[214:215], v[222:223], v[206:207] neg_lo:[0,0,1] neg_hi:[0,0,1]
    v_cvt_pk_bf16_f32 v124, v124, v125
    v_cvt_pk_bf16_f32 v125, v126, v127
    ds_write_b64 v7, v[120:121] offset:0
    ds_write_b64 v7, v[124:125] offset:3808
    v_mul_f32 v25, v25, v27
    v_mul_f32 v26, v26, v27
    s_mov_b32 s67, 0
    s_waitcnt vmcnt(6)
L_xc2:
    v_xor_b32 v60, s9, v129
    v_xor_b32 v61, s9, v131
    v_xor_b32 v62, s9, v133
    v_xor_b32 v63, s9, v135
    v_and_b32 v62, s26, v62
    v_and_b32 v63, s27, v63
    v_or3_b32 v60, v60, v61, v62
    v_or_b32 v60, v60, v63
    v_cmp_ne_u32 vcc, 0, v60
    s_and_b64 vcc, vcc, s[14:15]
    s_cbranch_vccnz L_xc2_retry
L_xc2_done:
    s_waitcnt lgkmcnt(0)
    s_barrier
    ds_read_b128 a[192:195], v3 offset:560
    ds_read_b128 a[196:199], v3 offset:2736
    ds_read_b128 a[200:203], v3 offset:1104
    ds_read_b128 a[204:207], v3 offset:3280
    ds_read_b128 a[208:211], v3 offset:16
    v_and_b32 v192, s78, v132
    v_lshlrev_b32 v193, 16, v128
    v_and_b32 v194, s78, v128
    v_lshlrev_b32 v195, 16, v130
    v_and_b32 v196, s78, v130
    v_lshlrev_b32 v197, 16, v134
    v_fma_f32 v192, v192, v25, v26
    v_fma_f32 v193, v193, v25, v26
    v_fma_f32 v194, v194, v25, v26
    v_fma_f32 v195, v195, v25, v26
    v_fma_f32 v196, v196, v25, v26
    v_fma_f32 v197, v197, v25, v26
    v_exp_f32 v216, v192
    v_exp_f32 v217, v193
    v_exp_f32 v218, v194
    v_exp_f32 v219, v195
    v_exp_f32_e64 v220, v196
    v_exp_f32_e64 v221, v197
    s_waitcnt lgkmcnt(4)
    v_mfma_f32_32x32x16_bf16 v[48:63], a[192:195], a[0:3], 0
    s_waitcnt lgkmcnt(3)
    ds_read_b128 a[212:215], v3 offset:2192
    s_add_u32 s76, s76, 4096
    buffer_load_dwordx4 a[112:115], v2, s[48:51], s76 offen offset:0 sc1
    ds_read_b128 v[240:243], v11 offset:64
    ds_read_b128 v[244:247], v11 offset:96
    v_fma_f32 v216, v216, s64, v254
    v_fma_f32 v217, v217, s64, s64
    v_fma_f32 v218, v218, s64, s64
    v_fma_f32 v219, v219, s64, s64
    v_mfma_f32_32x32x16_bf16 v[112:127], a[196:199], a[0:3], 0
    s_waitcnt lgkmcnt(5)
    ds_read_b128 a[216:219], v3 offset:1648
    v_fma_f32 v220, v220, s64, s64
    v_fma_f32 v221, v221, s64, v255
    v_rcp_f32 v216, v216
    v_rcp_f32 v217, v217
    v_rcp_f32_e64 v218, v218
    v_mfma_f32_32x32x16_bf16 v[64:79], a[200:203], a[4:7], 0
    s_waitcnt lgkmcnt(5)
    ds_read_b128 a[220:223], v3 offset:3824
    buffer_load_dwordx4 a[116:119], v2, s[48:51], s76 offen offset:1024 sc1
    v_rcp_f32 v219, v219
    v_rcp_f32 v220, v220
    v_rcp_f32 v221, v221
    v_mul_f32 v194, v194, v218
    v_mfma_f32_32x32x16_bf16 v[128:143], a[204:207], a[4:7], 0
    s_waitcnt lgkmcnt(5)
    ds_read_b128 a[192:195], v4 offset:560
    v_mul_f32 v195, v195, v219
    v_fma_f32 v200, v192, v216, -v194
    v_fma_f32 v201, v193, v217, v194
    v_fma_f32 v202, -v193, v217, v194
    v_fma_f32 v203, -v193, v217, v195
    v_fma_f32 v204, -v196, v220, v194
    v_fma_f32 v205, v196, v220, v195
    v_fma_f32 v206, v196, v220, -v195
    v_fma_f32 v207, v197, v221, -v195
    v_mfma_f32_32x32x16_bf16 v[32:47], a[208:211], a[8:11], v[32:47]
    s_waitcnt lgkmcnt(5)
    ds_read_b128 a[196:199], v4 offset:2736
    buffer_load_dwordx4 a[120:123], v2, s[48:51], s76 offen offset:2048 sc1
    v_cvt_pk_bf16_f32 v212, v200, v201
    v_cvt_pk_bf16_f32 v213, v202, v203
    v_cvt_pk_bf16_f32 v214, v204, v205
    v_cvt_pk_bf16_f32 v215, v206, v207
    v_mfma_f32_32x32x16_bf16 v[96:111], a[212:215], a[8:11], v[96:111]
    s_waitcnt lgkmcnt(3)
    ds_read_b128 a[200:203], v4 offset:1104
    buffer_load_dwordx4 a[124:127], v2, s[48:51], s76 offen offset:3072 sc1
    ds_write_b16 v8, v212 offset:0
    ds_write_b16_d16_hi v8, v212 offset:544
    ds_write_b16 v8, v213 offset:1088
    v_mfma_f32_32x32x16_bf16 v[80:95], a[216:219], a[12:15], v[80:95]
    s_waitcnt lgkmcnt(6)
    ds_read_b128 a[204:207], v4 offset:3280
    ds_write_b16_d16_hi v8, v213 offset:1632
    ds_write_b16 v8, v214 offset:2176
    ds_write_b16_d16_hi v8, v214 offset:2720
    ds_write_b16 v8, v215 offset:3264
    v_mfma_f32_32x32x16_bf16 v[144:159], a[220:223], a[12:15], v[144:159]
    s_waitcnt lgkmcnt(10)
    ds_read_b128 a[208:211], v4 offset:16
    s_add_u32 s76, s76, 4096
    buffer_load_dwordx4 a[128:131], v2, s[48:51], s76 offen offset:0 sc1
    ds_write_b16_d16_hi v8, v215 offset:3808
    v_mfma_f32_32x32x16_bf16 v[48:63], a[192:195], a[16:19], v[48:63]
    s_waitcnt lgkmcnt(11)
    ds_read_b128 a[212:215], v4 offset:2192
    v_lshlrev_b32 v200, 16, v170
    v_and_b32_e64 v201, s78, v170
    v_fma_f32 v200, v200, v240, v244
    v_lshlrev_b32 v202, 16, v171
    v_fma_f32 v201, v201, v241, v245
    v_exp_f32 v216, v200
    v_and_b32_e64 v203, s78, v171
    v_fma_f32 v202, v202, v242, v246
    v_mfma_f32_32x32x16_bf16 v[112:127], a[196:199], a[16:19], v[112:127]
    s_waitcnt lgkmcnt(11)
    ds_read_b128 a[216:219], v4 offset:1648
    buffer_load_dwordx4 a[132:135], v2, s[48:51], s76 offen offset:1024 sc1
    v_exp_f32 v217, v201
    v_lshlrev_b32 v204, 16, v178
    v_fma_f32 v203, v203, v243, v247
    v_exp_f32 v218, v202
    v_fma_f32 v216, v216, s64, s64
    v_mfma_f32_32x32x16_bf16 v[64:79], a[200:203], a[20:23], v[64:79]
L_hop4:
    s_cbranch_execz L_hop_ret
    s_waitcnt lgkmcnt(2)
    s_barrier
    ds_read_b128 a[220:223], v4 offset:3824
    buffer_load_dwordx4 a[136:139], v2, s[48:51], s76 offen offset:2048 sc1
    v_and_b32 v205, s78, v178
    v_fma_f32 v204, v204, v240, v244
    v_exp_f32_e64 v219, v203
    v_fma_f32 v217, v217, s64, s64
    v_mfma_f32_32x32x16_bf16 v[128:143], a[204:207], a[20:23], v[128:143]
    ds_read_b128 a[192:195], v3 offset:544
    v_rcp_f32 v216, v216
    v_lshlrev_b32 v206, 16, v179
    v_fma_f32 v205, v205, v241, v245
    v_exp_f32 v220, v204
    v_fma_f32 v218, v218, s64, s64
    v_rcp_f32 v217, v217
    v_and_b32 v207, s78, v179
    v_mfma_f32_32x32x16_bf16 v[32:47], a[208:211], a[24:27], v[32:47]
    s_waitcnt lgkmcnt(3)
    ds_read_b128 a[196:199], v3 offset:2720
    buffer_load_dwordx4 a[140:143], v2, s[48:51], s76 offen offset:3072 sc1
    v_fma_f32 v206, v206, v242, v246
    v_exp_f32_e64 v221, v205
    v_fma_f32 v219, v219, s64, s64
    v_mul_f32 v200, v200, v216
    v_rcp_f32 v218, v218
    v_lshlrev_b32 v196, 16, v162
    v_mfma_f32_32x32x16_bf16 v[96:111], a[212:215], a[24:27], v[96:111]
    s_waitcnt lgkmcnt(3)
    ds_read_b128 a[200:203], v3 offset:1088
    s_add_u32 s76, s76, 4096
    buffer_load_dwordx4 a[144:147], v2, s[48:51], s76 offen offset:0 sc1
    v_fma_f32 v207, v207, v243, v247
    v_exp_f32 v222, v206
    v_fma_f32 v220, v220, s64, s64
    v_mul_f32 v201, v201, v217
    v_rcp_f32 v219, v219
    v_mfma_f32_32x32x16_bf16 v[80:95], a[216:219], a[28:31], v[80:95]
    s_waitcnt lgkmcnt(3)
    ds_read_b128 a[204:207], v3 offset:3264
    v_and_b32 v197, s78, v162
    v_fma_f32 v196, v196, v240, v244
    v_exp_f32 v223, v207
    v_fma_f32 v221, v221, s64, s64
    v_mul_f32 v202, v202, v218
    v_rcp_f32 v220, v220
    v_lshlrev_b32 v198, 16, v163
    v_fma_f32 v197, v197, v241, v245
    v_mfma_f32_32x32x16_bf16 v[144:159], a[220:223], a[28:31], v[144:159]
    s_waitcnt lgkmcnt(3)
    ds_read_b128 a[208:211], v3 offset:0
    buffer_load_dwordx4 a[148:151], v2, s[48:51], s76 offen offset:1024 sc1
    v_exp_f32 v216, v196
    v_fma_f32 v222, v222, s64, s64
    v_mul_f32 v203, v203, v219
    v_rcp_f32 v221, v221
    v_and_b32_e64 v199, s78, v163
    v_mfma_f32_32x32x16_bf16 v[48:63], a[192:195], a[32:35], v[48:63]
    s_waitcnt lgkmcnt(3)
    ds_read_b128 a[212:215], v3 offset:2176
    buffer_load_dwordx4 a[152:155], v2, s[48:51], s76 offen offset:2048 sc1
    v_fma_f32 v198, v198, v242, v246
    v_exp_f32 v217, v197
    v_fma_f32 v223, v223, s64, s64
    v_mul_f32 v204, v204, v220
    v_rcp_f32 v222, v222
    v_lshlrev_b32_e64 v208, 16, v186
    v_mfma_f32_32x32x16_bf16 v[112:127], a[196:199], a[32:35], v[112:127]
    s_waitcnt lgkmcnt(3)
    ds_read_b128 a[216:219], v3 offset:1632
    buffer_load_dwordx4 a[156:159], v2, s[48:51], s76 offen offset:3072 sc1
    v_fma_f32 v199, v199, v243, v247
    v_exp_f32 v218, v198
    v_fma_f32 v216, v216, s64, s64
    v_mul_f32 v205, v205, v221
    v_rcp_f32 v223, v223
    v_and_b32_e64 v209, s78, v186
    v_mfma_f32_32x32x16_bf16 v[64:79], a[200:203], a[36:39], v[64:79]
    s_waitcnt lgkmcnt(3)
    ds_read_b128 a[220:223], v3 offset:3808
    v_fma_f32 v208, v208, v240, v244
    v_exp_f32 v219, v199
    v_fma_f32 v217, v217, s64, s64
    v_mul_f32 v206, v206, v222
    v_rcp_f32_e64 v216, v216
    v_lshlrev_b32 v210, 16, v187
    v_fma_f32 v209, v209, v241, v245
    v_mfma_f32_32x32x16_bf16 v[128:143], a[204:207], a[36:39], v[128:143]
    s_waitcnt lgkmcnt(3)
    ds_read_b128 a[192:195], v4 offset:544
    s_add_u32 s76, s76, 4096
    buffer_load_dwordx4 a[160:163], v2, s[48:51], s76 offen offset:0 sc1
    v_exp_f32 v220, v208
    v_fma_f32 v218, v218, s64, s64
    v_mul_f32 v207, v207, v223
    v_rcp_f32 v217, v217
    v_mfma_f32_32x32x16_bf16 v[32:47], a[208:211], a[40:43], v[32:47]
    s_waitcnt lgkmcnt(3)
    ds_read_b128 a[196:199], v4 offset:2720
    buffer_load_dwordx4 a[164:167], v2, s[48:51], s76 offen offset:1024 sc1
    v_and_b32 v211, s78, v187
    v_fma_f32 v210, v210, v242, v246
    v_exp_f32 v221, v209
    v_fma_f32 v219, v219, s64, s64
    v_fma_f32 v248, v196, v216, v200
    v_fma_f32 v250, -v196, v216, v200
    v_mfma_f32_32x32x16_bf16 v[96:111], a[212:215], a[40:43], v[96:111]
    s_waitcnt lgkmcnt(3)
    ds_read_b128 a[200:203], v4 offset:1088
    v_rcp_f32 v218, v218
    v_fma_f32 v252, -v196, v216, v204
    v_lshlrev_b32 v192, 16, v226
    v_fma_f32 v211, v211, v243, v247
    v_exp_f32 v222, v210
    v_fma_f32 v220, v220, s64, s64
    v_fma_f32 v249, v197, v217, v201
    v_fma_f32 v251, -v197, v217, v201
    v_mfma_f32_32x32x16_bf16 v[80:95], a[216:219], a[44:47], v[80:95]
    s_waitcnt lgkmcnt(3)
    ds_read_b128 a[204:207], v4 offset:3264
    buffer_load_dwordx4 a[168:171], v2, s[48:51], s76 offen offset:2048 sc1
    v_rcp_f32 v219, v219
    v_fma_f32 v253, -v197, v217, v205
    v_cvt_pk_bf16_f32 v248, v248, v249
    v_cvt_pk_bf16_f32 v250, v250, v251
    v_cvt_pk_bf16_f32 v252, v252, v253
    v_and_b32_e64 v193, s78, v226
    v_fma_f32 v192, v192, v240, v244
    v_mfma_f32_32x32x16_bf16 v[144:159], a[220:223], a[44:47], v[144:159]
    s_waitcnt lgkmcnt(3)
    ds_read_b128 a[208:211], v4 offset:0
    buffer_load_dwordx4 a[172:175], v2, s[48:51], s76 offen offset:3072 sc1
    v_exp_f32 v223, v211
    v_fma_f32 v221, v221, s64, s64
    v_fma_f32 v249, v198, v218, v202
    v_fma_f32 v251, -v198, v218, v202
    v_rcp_f32_e64 v220, v220
    v_fma_f32 v253, -v198, v218, v206
    v_mfma_f32_32x32x16_bf16 v[48:63], a[192:195], a[48:51], v[48:63]
    s_waitcnt lgkmcnt(3)
    ds_read_b128 a[212:215], v4 offset:2176
    v_lshlrev_b32 v194, 16, v227
    v_fma_f32 v193, v193, v241, v245
    v_exp_f32_e64 v216, v192
    v_fma_f32 v222, v222, s64, s64
    v_fma_f32 v30, v199, v219, v203
    v_fma_f32 v31, -v199, v219, v203
    v_rcp_f32 v221, v221
    v_fma_f32 v29, -v199, v219, v207
    v_mfma_f32_32x32x16_bf16 v[112:127], a[196:199], a[48:51], v[112:127]
    s_waitcnt lgkmcnt(3)
    ds_read_b128 a[216:219], v4 offset:1632
    s_add_u32 s76, s76, 4096
    buffer_load_dwordx4 a[176:179], v2, s[48:51], s76 offen offset:0 sc1
    v_cvt_pk_bf16_f32 v249, v249, v30
    v_cvt_pk_bf16_f32 v251, v251, v31
    v_cvt_pk_bf16_f32 v253, v253, v29
    v_mfma_f32_32x32x16_bf16 v[64:79], a[200:203], a[52:55], v[64:79]
    s_waitcnt lgkmcnt(3)
    ds_read_b128 a[220:223], v4 offset:3808
    buffer_load_dwordx4 a[180:183], v2, s[48:51], s76 offen offset:1024 sc1
    ds_write_b64 v7, v[248:249] offset:4928
    ds_write_b64 v7, v[250:251] offset:5472
    v_mfma_f32_32x32x16_bf16 v[128:143], a[204:207], a[52:55], v[128:143]
    s_waitcnt lgkmcnt(5)
    ds_read_b128 a[192:195], v3 offset:576
    ds_write_b64 v7, v[252:253] offset:6016
    v_and_b32_e64 v195, s78, v227
    v_fma_f32 v194, v194, v242, v246
    v_exp_f32_e64 v217, v193
    v_fma_f32 v223, v223, s64, s64
    v_fma_f32 v170, -v208, v220, v200
    v_fma_f32 v178, v208, v220, v204
    v_mfma_f32_32x32x16_bf16 v[32:47], a[208:211], a[56:59], v[32:47]
    s_waitcnt lgkmcnt(6)
    ds_read_b128 a[196:199], v3 offset:2752
    buffer_load_dwordx4 a[184:187], v2, s[48:51], s76 offen offset:2048 sc1
    v_rcp_f32 v222, v222
    v_fma_f32 v162, v208, v220, -v204
    v_lshlrev_b32_e64 v212, 16, v234
    v_fma_f32 v195, v195, v243, v247
    v_exp_f32 v218, v194
    v_fma_f32 v216, v216, s64, v254
    v_mfma_f32_32x32x16_bf16 v[96:111], a[212:215], a[56:59], v[96:111]
    s_waitcnt lgkmcnt(6)
    ds_read_b128 a[200:203], v3 offset:1120
    buffer_load_dwordx4 a[188:191], v2, s[48:51], s76 offen offset:3072 sc1
    v_fma_f32 v171, -v209, v221, v201
    v_fma_f32 v179, v209, v221, v205
    v_rcp_f32_e64 v223, v223
    v_fma_f32 v163, v209, v221, -v205
    v_cvt_pk_bf16_f32 v170, v170, v171
    v_cvt_pk_bf16_f32 v178, v178, v179
    v_cvt_pk_bf16_f32 v162, v162, v163
    v_mfma_f32_32x32x16_bf16 v[80:95], a[216:219], a[60:63], v[80:95]
    s_waitcnt lgkmcnt(6)
    ds_read_b128 a[204:207], v3 offset:3296
    v_and_b32 v213, s78, v234
    v_fma_f32 v212, v212, v240, v244
    v_exp_f32_e64 v219, v195
    v_fma_f32 v217, v217, s64, v254
    v_fma_f32 v171, -v210, v222, v202
    v_fma_f32 v179, v210, v222, v206
    v_rcp_f32 v216, v216
    v_fma_f32 v163, v210, v222, -v206
    v_mfma_f32_32x32x16_bf16 v[144:159], a[220:223], a[60:63], v[144:159]
    s_waitcnt lgkmcnt(4)
    ds_read_b128 a[208:211], v3 offset:32
    s_add_u32 s76, s76, 4096
    buffer_load_dwordx4 a[0:3], v2, s[48:51], s76 offen offset:0 sc1
    v_lshlrev_b32 v214, 16, v235
    v_fma_f32 v213, v213, v241, v245
    v_exp_f32 v220, v212
    v_fma_f32 v218, v218, s64, v254
    v_fma_f32 v30, -v211, v223, v203
    v_fma_f32 v31, v211, v223, v207
    v_mfma_f32_32x32x16_bf16 v[48:63], a[192:195], a[64:67], v[48:63]
    s_waitcnt lgkmcnt(3)
    ds_read_b128 a[212:215], v3 offset:2208
    buffer_load_dwordx4 a[4:7], v2, s[48:51], s76 offen offset:1024 sc1
    v_rcp_f32 v217, v217
    v_fma_f32 v29, v211, v223, -v207
    v_cvt_pk_bf16_f32 v171, v171, v30
    v_cvt_pk_bf16_f32 v179, v179, v31
    v_cvt_pk_bf16_f32 v163, v163, v29
    v_mfma_f32_32x32x16_bf16 v[112:127], a[196:199], a[64:67], v[112:127]
    s_waitcnt lgkmcnt(3)
    ds_read_b128 a[216:219], v3 offset:1664
    ds_write_b64 v7, v[170:171] offset:6560
    ds_write_b64 v7, v[178:179] offset:7104
    ds_write_b64 v7, v[162:163] offset:7648
    v_mfma_f32_32x32x16_bf16 v[64:79], a[200:203], a[68:71], v[64:79]
    s_waitcnt lgkmcnt(6)
    ds_read_b128 a[220:223], v3 offset:3840
    buffer_load_dwordx4 a[8:11], v2, s[48:51], s76 offen offset:2048 sc1
    v_and_b32 v215, s78, v235
    v_fma_f32 v214, v214, v242, v246
    v_exp_f32 v221, v213
    v_fma_f32 v219, v219, s64, v254
    v_fma_f32 v186, v192, v216, -v200
    v_rcp_f32 v218, v218
    v_mfma_f32_32x32x16_bf16 v[128:143], a[204:207], a[68:71], v[128:143]
    s_waitcnt lgkmcnt(6)
    ds_read_b128 a[192:195], v4 offset:576
    buffer_load_dwordx4 a[12:15], v2, s[48:51], s76 offen offset:3072 sc1
    v_fma_f32 v215, v215, v243, v247
    v_exp_f32_e64 v222, v214
    v_fma_f32 v220, v220, s64, v255
    v_fma_f32 v187, v193, v217, -v201
    v_cvt_pk_bf16_f32 v186, v186, v187
    v_rcp_f32 v219, v219
    v_mfma_f32_32x32x16_bf16 v[32:47], a[208:211], a[72:75], v[32:47]
    s_waitcnt lgkmcnt(6)
    ds_read_b128 a[196:199], v4 offset:2752
    s_add_u32 s76, s76, 4096
    buffer_load_dwordx4 a[16:19], v2, s[48:51], s76 offen offset:0 sc1
    v_exp_f32_e64 v223, v215
    v_fma_f32 v221, v221, s64, v255
    v_fma_f32 v187, v194, v218, -v202
    v_rcp_f32_e64 v220, v220
    v_fma_f32 v222, v222, s64, v255
    v_fma_f32 v30, v195, v219, -v203
    v_mfma_f32_32x32x16_bf16 v[96:111], a[212:215], a[72:75], v[96:111]
    s_waitcnt lgkmcnt(6)
    ds_read_b128 a[200:203], v4 offset:1120
    v_cvt_pk_bf16_f32 v187, v187, v30
    v_rcp_f32 v221, v221
    v_fma_f32 v223, v223, s64, v255
    v_fma_f32 v248, v212, v220, -v204
    v_rcp_f32_e64 v222, v222
    v_fma_f32 v249, v213, v221, -v205
    v_cvt_pk_bf16_f32 v248, v248, v249
    v_rcp_f32 v223, v223
    v_mfma_f32_32x32x16_bf16 v[80:95], a[216:219], a[76:79], v[80:95]
    s_waitcnt lgkmcnt(3)
    ds_read_b128 a[204:207], v4 offset:3296
    buffer_load_dwordx4 a[20:23], v2, s[48:51], s76 offen offset:1024 sc1
    ds_write_b64 v7, v[186:187] offset:4384
    v_fma_f32 v249, v214, v222, -v206
    v_fma_f32 v30, v215, v223, -v207
    v_mfma_f32_32x32x16_bf16 v[144:159], a[220:223], a[76:79], v[144:159]
    s_waitcnt lgkmcnt(4)
    ds_read_b128 a[208:211], v4 offset:32
    buffer_load_dwordx4 a[24:27], v2, s[48:51], s76 offen offset:2048 sc1
    v_cvt_pk_bf16_f32 v249, v249, v30
    v_mfma_f32_32x32x16_bf16 v[48:63], a[192:195], a[80:83], v[48:63]
    s_waitcnt lgkmcnt(4)
    ds_read_b128 a[212:215], v4 offset:2208
    ds_write_b64 v7, v[248:249] offset:8192
    buffer_load_dwordx4 v[228:231], v6, s[48:51], s73 offen sc1
    buffer_load_dwordx4 v[236:239], v6, s[48:51], s75 offen sc1
    v_mfma_f32_32x32x16_bf16 v[112:127], a[196:199], a[80:83], v[112:127]
    s_waitcnt lgkmcnt(5)
    ds_read_b128 a[216:219], v4 offset:1664
    buffer_load_dwordx4 a[28:31], v2, s[48:51], s76 offen offset:3072 sc1
    ds_read_b128 v[240:243], v11 offset:128
    ds_read_b128 v[244:247], v11 offset:160
    v_lshlrev_b32 v200, 16, v172
    v_and_b32_e64 v201, s78, v172
    v_mfma_f32_32x32x16_bf16 v[64:79], a[200:203], a[84:87], v[64:79]
    s_waitcnt lgkmcnt(3)
    s_barrier
    ds_read_b128 a[220:223], v4 offset:3840
    v_mfma_f32_32x32x16_bf16 v[128:143], a[204:207], a[84:87], v[128:143]
    s_waitcnt vmcnt(35)
    ds_read_b128 a[192:195], v3 offset:4944
    s_add_u32 s76, s76, 4096
    buffer_load_dwordx4 a[32:35], v2, s[48:51], s76 offen offset:0 sc1
    v_mfma_f32_32x32x16_bf16 v[32:47], a[208:211], a[88:91], v[32:47]
    s_waitcnt lgkmcnt(2)
    ds_read_b128 a[196:199], v3 offset:7120
    v_fma_f32 v200, v200, v240, v244
    v_lshlrev_b32 v202, 16, v173
    v_fma_f32 v201, v201, v241, v245
    v_exp_f32 v216, v200
    v_and_b32_e64 v203, s78, v173
    v_fma_f32 v202, v202, v242, v246
    v_mfma_f32_32x32x16_bf16 v[96:111], a[212:215], a[88:91], v[96:111]
    s_waitcnt vmcnt(35)
    ds_read_b128 a[200:203], v3 offset:5488
    buffer_load_dwordx4 a[36:39], v2, s[48:51], s76 offen offset:1024 sc1
    v_exp_f32 v217, v201
    v_lshlrev_b32 v204, 16, v180
    v_fma_f32 v203, v203, v243, v247
    v_mfma_f32_32x32x16_bf16 v[80:95], a[216:219], a[92:95], v[80:95]
    s_waitcnt lgkmcnt(3)
    ds_read_b128 a[204:207], v3 offset:7664
    v_exp_f32 v218, v202
    v_fma_f32 v216, v216, s64, s64
    v_and_b32 v205, s78, v180
    v_fma_f32 v204, v204, v240, v244
    v_exp_f32_e64 v219, v203
    v_mfma_f32_32x32x16_bf16 v[144:159], a[220:223], a[92:95], v[144:159]
    s_waitcnt vmcnt(35) lgkmcnt(3)
    ds_read_b128 a[208:211], v3 offset:4400
    buffer_load_dwordx4 a[40:43], v2, s[48:51], s76 offen offset:2048 sc1
    v_fma_f32 v217, v217, s64, s64
    v_rcp_f32 v216, v216
    v_lshlrev_b32 v206, 16, v181
    v_fma_f32 v205, v205, v241, v245
    v_mfma_f32_32x32x16_bf16 v[48:63], a[192:195], a[96:99], v[48:63]
    s_waitcnt lgkmcnt(3)
    ds_read_b128 a[212:215], v3 offset:6576
    v_exp_f32 v220, v204
    v_fma_f32 v218, v218, s64, s64
    v_rcp_f32 v217, v217
    v_and_b32_e64 v207, s78, v181
    v_fma_f32 v206, v206, v242, v246
    v_mfma_f32_32x32x16_bf16 v[112:127], a[196:199], a[96:99], v[112:127]
    s_waitcnt vmcnt(35) lgkmcnt(3)
    ds_read_b128 a[216:219], v3 offset:6032
    buffer_load_dwordx4 a[44:47], v2, s[48:51], s76 offen offset:3072 sc1
    v_exp_f32 v221, v205
    v_fma_f32 v219, v219, s64, s64
    v_mul_f32 v200, v200, v216
    v_mfma_f32_32x32x16_bf16 v[64:79], a[200:203], a[100:103], v[64:79]
    s_waitcnt lgkmcnt(3)
    ds_read_b128 a[220:223], v3 offset:8208
    v_rcp_f32 v218, v218
    v_lshlrev_b32 v196, 16, v164
    v_fma_f32 v207, v207, v243, v247
    v_exp_f32_e64 v222, v206
    v_fma_f32 v220, v220, s64, s64
    v_mfma_f32_32x32x16_bf16 v[128:143], a[204:207], a[100:103], v[128:143]
    s_waitcnt vmcnt(35) lgkmcnt(3)
    ds_read_b128 a[192:195], v4 offset:4944
    s_add_u32 s76, s76, 4096
    buffer_load_dwordx4 a[48:51], v2, s[48:51], s76 offen offset:0 sc1
    v_mul_f32 v201, v201, v217
    v_rcp_f32 v219, v219
    v_and_b32 v197, s78, v164
    v_mfma_f32_32x32x16_bf16 v[32:47], a[208:211], a[104:107], v[32:47]
    s_waitcnt lgkmcnt(3)
    ds_read_b128 a[196:199], v4 offset:7120
    v_fma_f32 v196, v196, v240, v244
    v_exp_f32 v223, v207
    v_fma_f32 v221, v221, s64, s64
    v_mul_f32 v202, v202, v218
    v_rcp_f32_e64 v220, v220
    v_mfma_f32_32x32x16_bf16 v[96:111], a[212:215], a[104:107], v[96:111]
    s_waitcnt vmcnt(35) lgkmcnt(3)
    ds_read_b128 a[200:203], v4 offset:5488
    buffer_load_dwordx4 a[52:55], v2, s[48:51], s76 offen offset:1024 sc1
    v_lshlrev_b32 v198, 16, v165
    v_fma_f32 v197, v197, v241, v245
    v_exp_f32 v216, v196
    v_fma_f32 v222, v222, s64, s64
    v_mfma_f32_32x32x16_bf16 v[80:95], a[216:219], a[108:111], v[80:95]
    s_waitcnt lgkmcnt(3)
    ds_read_b128 a[204:207], v4 offset:7664
    buffer_load_dwordx4 a[56:59], v2, s[48:51], s76 offen offset:2048 sc1
    v_mul_f32 v203, v203, v219
    v_rcp_f32 v221, v221
    v_and_b32_e64 v199, s78, v165
    v_fma_f32 v198, v198, v242, v246
    v_mfma_f32_32x32x16_bf16 v[144:159], a[220:223], a[108:111], v[144:159]
    s_waitcnt vmcnt(36) lgkmcnt(3)
    ds_read_b128 a[208:211], v4 offset:4400
    v_exp_f32 v217, v197
    v_fma_f32 v223, v223, s64, s64
    v_mul_f32 v204, v204, v220
    v_rcp_f32_e64 v222, v222
    v_lshlrev_b32 v208, 16, v188
    v_mfma_f32_32x32x16_bf16 v[48:63], a[192:195], a[112:115], v[48:63]
    s_waitcnt lgkmcnt(3)
    ds_read_b128 a[212:215], v4 offset:6576
    buffer_load_dwordx4 a[60:63], v2, s[48:51], s76 offen offset:3072 sc1
    v_fma_f32 v199, v199, v243, v247
    v_exp_f32 v218, v198
    v_fma_f32 v216, v216, s64, s64
    v_mul_f32 v205, v205, v221
    v_mfma_f32_32x32x16_bf16 v[112:127], a[196:199], a[112:115], v[112:127]
    s_waitcnt vmcnt(36) lgkmcnt(3)
    ds_read_b128 a[216:219], v4 offset:6032
    v_rcp_f32 v223, v223
    v_and_b32_e64 v209, s78, v188
    v_fma_f32 v208, v208, v240, v244
    v_exp_f32 v219, v199
    v_fma_f32 v217, v217, s64, s64
    v_mfma_f32_32x32x16_bf16 v[64:79], a[200:203], a[116:119], v[64:79]
    s_waitcnt lgkmcnt(3)
    ds_read_b128 a[220:223], v4 offset:8208
    s_add_u32 s76, s76, 4096
    buffer_load_dwordx4 a[64:67], v2, s[48:51], s76 offen offset:0 sc1
    v_mul_f32 v206, v206, v222
    v_rcp_f32 v216, v216
    v_lshlrev_b32_e64 v210, 16, v189
    v_mfma_f32_32x32x16_bf16 v[128:143], a[204:207], a[116:119], v[128:143]
    s_waitcnt vmcnt(36) lgkmcnt(3)
    ds_read_b128 a[192:195], v3 offset:4928
    v_fma_f32 v209, v209, v241, v245
    v_exp_f32 v220, v208
    v_fma_f32 v218, v218, s64, s64
    v_mul_f32 v207, v207, v223
    v_rcp_f32_e64 v217, v217
    v_mfma_f32_32x32x16_bf16 v[32:47], a[208:211], a[120:123], v[32:47]
    s_waitcnt lgkmcnt(3)
    ds_read_b128 a[196:199], v3 offset:7104
    buffer_load_dwordx4 a[68:71], v2, s[48:51], s76 offen offset:1024 sc1
    v_and_b32_e64 v211, s78, v189
    v_fma_f32 v210, v210, v242, v246
    v_exp_f32 v221, v209
    v_fma_f32 v219, v219, s64, s64
    v_mfma_f32_32x32x16_bf16 v[96:111], a[212:215], a[120:123], v[96:111]
    s_waitcnt vmcnt(12) lgkmcnt(3)
    ds_read_b128 a[200:203], v3 offset:5472
    v_fma_f32 v248, v196, v216, v200
    v_fma_f32 v250, -v196, v216, v200
    v_rcp_f32_e64 v218, v218
    v_fma_f32 v252, -v196, v216, v204
    v_lshlrev_b32 v192, 16, v228
    v_fma_f32 v211, v211, v243, v247
    v_mfma_f32_32x32x16_bf16 v[80:95], a[216:219], a[124:127], v[80:95]
    s_waitcnt lgkmcnt(3)
    ds_read_b128 a[204:207], v3 offset:7648
    buffer_load_dwordx4 a[72:75], v2, s[48:51], s76 offen offset:2048 sc1
    v_exp_f32_e64 v222, v210
    v_fma_f32 v220, v220, s64, s64
    v_fma_f32 v249, v197, v217, v201
    v_fma_f32 v251, -v197, v217, v201
    v_mfma_f32_32x32x16_bf16 v[144:159], a[220:223], a[124:127], v[144:159]
    s_waitcnt lgkmcnt(3)
    ds_read_b128 a[208:211], v3 offset:4384
    buffer_load_dwordx4 a[76:79], v2, s[48:51], s76 offen offset:3072 sc1
    v_rcp_f32 v219, v219
    v_fma_f32 v253, -v197, v217, v205
    v_cvt_pk_bf16_f32 v248, v248, v249
    v_cvt_pk_bf16_f32 v250, v250, v251
    v_mfma_f32_32x32x16_bf16 v[48:63], a[192:195], a[128:131], v[48:63]
    s_waitcnt lgkmcnt(3)
    ds_read_b128 a[212:215], v3 offset:6560
    v_cvt_pk_bf16_f32 v252, v252, v253
    v_and_b32 v193, s78, v228
    v_fma_f32 v192, v192, v240, v244
    v_exp_f32_e64 v223, v211
    v_fma_f32 v221, v221, s64, s64
    v_fma_f32 v249, v198, v218, v202
    v_mfma_f32_32x32x16_bf16 v[112:127], a[196:199], a[128:131], v[112:127]
    s_waitcnt lgkmcnt(3)
    ds_read_b128 a[216:219], v3 offset:6016
    s_add_u32 s76, s76, 4096
    buffer_load_dwordx4 a[80:83], v2, s[48:51], s76 offen offset:0 sc1
    v_fma_f32 v251, -v198, v218, v202
    v_rcp_f32 v220, v220
    v_fma_f32 v253, -v198, v218, v206
    v_mfma_f32_32x32x16_bf16 v[64:79], a[200:203], a[132:135], v[64:79]
    s_waitcnt lgkmcnt(3)
    ds_read_b128 a[220:223], v3 offset:8192
    v_lshlrev_b32 v194, 16, v229
    v_fma_f32 v193, v193, v241, v245
    v_exp_f32_e64 v216, v192
    v_fma_f32 v222, v222, s64, s64
    v_fma_f32 v30, v199, v219, v203
    v_fma_f32 v31, -v199, v219, v203
    v_mfma_f32_32x32x16_bf16 v[128:143], a[204:207], a[132:135], v[128:143]
    s_waitcnt lgkmcnt(3)
    ds_read_b128 a[192:195], v4 offset:4928
    buffer_load_dwordx4 a[84:87], v2, s[48:51], s76 offen offset:1024 sc1
    v_rcp_f32 v221, v221
    v_fma_f32 v29, -v199, v219, v207
    v_cvt_pk_bf16_f32 v249, v249, v30
    v_cvt_pk_bf16_f32 v251, v251, v31
    v_mfma_f32_32x32x16_bf16 v[32:47], a[208:211], a[136:139], v[32:47]
    s_waitcnt lgkmcnt(3)
    ds_read_b128 a[196:199], v4 offset:7104
    ds_write_b64 v7, v[248:249] offset:9312
    ds_write_b64 v7, v[250:251] offset:9856
    v_cvt_pk_bf16_f32 v253, v253, v29
    v_mfma_f32_32x32x16_bf16 v[96:111], a[212:215], a[136:139], v[96:111]
    s_waitcnt lgkmcnt(5)
    ds_read_b128 a[200:203], v4 offset:5472
    buffer_load_dwordx4 a[88:91], v2, s[48:51], s76 offen offset:2048 sc1
    ds_write_b64 v7, v[252:253] offset:10400
    v_and_b32 v195, s78, v229
    v_fma_f32 v194, v194, v242, v246
    v_mfma_f32_32x32x16_bf16 v[80:95], a[216:219], a[140:143], v[80:95]
    s_waitcnt lgkmcnt(6)
    ds_read_b128 a[204:207], v4 offset:7648
    v_exp_f32_e64 v217, v193
    v_fma_f32 v223, v223, s64, s64
    v_fma_f32 v172, -v208, v220, v200
    v_fma_f32 v180, v208, v220, v204
    v_rcp_f32 v222, v222
    v_mfma_f32_32x32x16_bf16 v[144:159], a[220:223], a[140:143], v[144:159]
    s_waitcnt vmcnt(16) lgkmcnt(6)
    ds_read_b128 a[208:211], v4 offset:4384
    buffer_load_dwordx4 a[92:95], v2, s[48:51], s76 offen offset:3072 sc1
    v_fma_f32 v164, v208, v220, -v204
    v_lshlrev_b32 v212, 16, v236
    v_fma_f32 v195, v195, v243, v247
    v_exp_f32 v218, v194
    v_mfma_f32_32x32x16_bf16 v[48:63], a[192:195], a[144:147], v[48:63]
    s_waitcnt lgkmcnt(6)
    ds_read_b128 a[212:215], v4 offset:6560
    s_add_u32 s76, s76, 4096
    buffer_load_dwordx4 a[96:99], v2, s[48:51], s76 offen offset:0 sc1
    v_fma_f32 v216, v216, s64, v254
    v_fma_f32 v173, -v209, v221, v201
    v_fma_f32 v181, v209, v221, v205
    v_mfma_f32_32x32x16_bf16 v[112:127], a[196:199], a[144:147], v[112:127]
    s_waitcnt lgkmcnt(4)
    ds_read_b128 a[216:219], v4 offset:6016
    v_rcp_f32_e64 v223, v223
    v_fma_f32 v165, v209, v221, -v205
    v_cvt_pk_bf16_f32 v172, v172, v173
    v_cvt_pk_bf16_f32 v180, v180, v181
    v_cvt_pk_bf16_f32 v164, v164, v165
    v_and_b32 v213, s78, v236
    v_mfma_f32_32x32x16_bf16 v[64:79], a[200:203], a[148:151], v[64:79]
    s_waitcnt lgkmcnt(3)
    ds_read_b128 a[220:223], v4 offset:8192
    buffer_load_dwordx4 a[100:103], v2, s[48:51], s76 offen offset:1024 sc1
    v_fma_f32 v212, v212, v240, v244
    v_exp_f32_e64 v219, v195
    v_fma_f32 v217, v217, s64, v254
    v_fma_f32 v173, -v210, v222, v202
    v_mfma_f32_32x32x16_bf16 v[128:143], a[204:207], a[148:151], v[128:143]
    s_waitcnt lgkmcnt(3)
    ds_read_b128 a[192:195], v3 offset:4960
    v_fma_f32 v181, v210, v222, v206
    v_rcp_f32 v216, v216
    v_fma_f32 v165, v210, v222, -v206
    v_lshlrev_b32_e64 v214, 16, v237
    v_fma_f32 v213, v213, v241, v245
    v_mfma_f32_32x32x16_bf16 v[32:47], a[208:211], a[152:155], v[32:47]
    s_waitcnt lgkmcnt(3)
    ds_read_b128 a[196:199], v3 offset:7136
    buffer_load_dwordx4 a[104:107], v2, s[48:51], s76 offen offset:2048 sc1
    v_exp_f32 v220, v212
    v_fma_f32 v218, v218, s64, v254
    v_fma_f32 v30, -v211, v223, v203
    v_fma_f32 v31, v211, v223, v207
    v_mfma_f32_32x32x16_bf16 v[96:111], a[212:215], a[152:155], v[96:111]
    s_waitcnt lgkmcnt(3)
    ds_read_b128 a[200:203], v3 offset:5504
    v_rcp_f32 v217, v217
    v_fma_f32 v29, v211, v223, -v207
    v_cvt_pk_bf16_f32 v173, v173, v30
    v_cvt_pk_bf16_f32 v181, v181, v31
    v_cvt_pk_bf16_f32 v165, v165, v29
    v_mfma_f32_32x32x16_bf16 v[80:95], a[216:219], a[156:159], v[80:95]
    s_waitcnt lgkmcnt(3)
    ds_read_b128 a[204:207], v3 offset:7680
    buffer_load_dwordx4 a[108:111], v2, s[48:51], s76 offen offset:3072 sc1
    ds_write_b64 v7, v[172:173] offset:10944
    ds_write_b64 v7, v[180:181] offset:11488
    v_mfma_f32_32x32x16_bf16 v[144:159], a[220:223], a[156:159], v[144:159]
    s_waitcnt lgkmcnt(5)
    ds_read_b128 a[208:211], v3 offset:4416
    ds_write_b64 v7, v[164:165] offset:12032
    v_and_b32 v215, s78, v237
    v_fma_f32 v214, v214, v242, v246
    v_exp_f32_e64 v221, v213
    v_mfma_f32_32x32x16_bf16 v[48:63], a[192:195], a[160:163], v[48:63]
    s_waitcnt lgkmcnt(6)
    ds_read_b128 a[212:215], v3 offset:6592
    s_add_u32 s76, s76, 4096
    buffer_load_dwordx4 a[112:115], v2, s[48:51], s76 offen offset:0 sc1
    v_fma_f32 v219, v219, s64, v254
    v_fma_f32 v188, v192, v216, -v200
    v_rcp_f32_e64 v218, v218
    v_mfma_f32_32x32x16_bf16 v[112:127], a[196:199], a[160:163], v[112:127]
L_hop5:
    s_cbranch_execz L_hop_ret
    s_waitcnt lgkmcnt(6)
    ds_read_b128 a[216:219], v3 offset:6048
    v_fma_f32 v215, v215, v243, v247
    v_exp_f32_e64 v222, v214
    v_fma_f32 v220, v220, s64, v255
    v_fma_f32 v189, v193, v217, -v201
    v_cvt_pk_bf16_f32 v188, v188, v189
    v_mfma_f32_32x32x16_bf16 v[64:79], a[200:203], a[164:167], v[64:79]
    s_waitcnt lgkmcnt(6)
    ds_read_b128 a[220:223], v3 offset:8224
    buffer_load_dwordx4 a[116:119], v2, s[48:51], s76 offen offset:1024 sc1
    v_rcp_f32 v219, v219
    v_exp_f32_e64 v223, v215
    v_fma_f32 v221, v221, s64, v255
    v_mfma_f32_32x32x16_bf16 v[128:143], a[204:207], a[164:167], v[128:143]
    s_waitcnt lgkmcnt(4)
    ds_read_b128 a[192:195], v4 offset:4960
    v_fma_f32 v189, v194, v218, -v202
    v_rcp_f32 v220, v220
    v_fma_f32 v222, v222, s64, v255
    v_fma_f32 v30, v195, v219, -v203
    v_cvt_pk_bf16_f32 v189, v189, v30
    v_rcp_f32_e64 v221, v221
    v_mfma_f32_32x32x16_bf16 v[32:47], a[208:211], a[168:171], v[32:47]
    s_waitcnt lgkmcnt(3)
    ds_read_b128 a[196:199], v4 offset:7136
    buffer_load_dwordx4 a[120:123], v2, s[48:51], s76 offen offset:2048 sc1
    ds_write_b64 v7, v[188:189] offset:8768
    v_fma_f32 v223, v223, s64, v255
    v_mfma_f32_32x32x16_bf16 v[96:111], a[212:215], a[168:171], v[96:111]
    s_waitcnt lgkmcnt(4)
    ds_read_b128 a[200:203], v4 offset:5504
    buffer_load_dwordx4 a[124:127], v2, s[48:51], s76 offen offset:3072 sc1
    v_fma_f32 v248, v212, v220, -v204
    v_rcp_f32_e64 v222, v222
    v_fma_f32 v249, v213, v221, -v205
    v_cvt_pk_bf16_f32 v248, v248, v249
    v_mfma_f32_32x32x16_bf16 v[80:95], a[216:219], a[172:175], v[80:95]
    s_waitcnt lgkmcnt(4)
    ds_read_b128 a[204:207], v4 offset:7680
    v_rcp_f32 v223, v223
    v_fma_f32 v249, v214, v222, -v206
    v_fma_f32 v30, v215, v223, -v207
    v_cvt_pk_bf16_f32 v249, v249, v30
    v_mfma_f32_32x32x16_bf16 v[144:159], a[220:223], a[172:175], v[144:159]
    s_waitcnt lgkmcnt(4)
    ds_read_b128 a[208:211], v4 offset:4416
    s_add_u32 s76, s76, 4096
    buffer_load_dwordx4 a[128:131], v2, s[48:51], s76 offen offset:0 sc1
    ds_write_b64 v7, v[248:249] offset:12576
    ds_read_b128 v[240:243], v11 offset:192
    v_mfma_f32_32x32x16_bf16 v[48:63], a[192:195], a[176:179], v[48:63]
    s_waitcnt lgkmcnt(6)
    ds_read_b128 a[212:215], v4 offset:6592
    ds_read_b128 v[244:247], v11 offset:224
    v_lshlrev_b32_e64 v200, 16, v174
    v_and_b32_e64 v201, s78, v174
    v_mfma_f32_32x32x16_bf16 v[112:127], a[196:199], a[176:179], v[112:127]
    s_waitcnt lgkmcnt(6)
    ds_read_b128 a[216:219], v4 offset:6048
    buffer_load_dwordx4 a[132:135], v2, s[48:51], s76 offen offset:1024 sc1
    v_mfma_f32_32x32x16_bf16 v[64:79], a[200:203], a[180:183], v[64:79]
    s_waitcnt lgkmcnt(4)
    s_barrier
    ds_read_b128 a[220:223], v4 offset:8224
    v_mfma_f32_32x32x16_bf16 v[128:143], a[204:207], a[180:183], v[128:143]
    s_waitcnt lgkmcnt(2)
    ds_read_b128 a[192:195], v3 offset:9328
    v_fma_f32 v200, v200, v240, v244
    v_lshlrev_b32 v202, 16, v175
    v_fma_f32 v201, v201, v241, v245
    v_exp_f32 v216, v200
    v_and_b32_e64 v203, s78, v175
    v_fma_f32 v202, v202, v242, v246
    v_mfma_f32_32x32x16_bf16 v[32:47], a[208:211], a[184:187], v[32:47]
    ds_read_b128 a[196:199], v3 offset:11504
    buffer_load_dwordx4 a[136:139], v2, s[48:51], s76 offen offset:2048 sc1
    v_exp_f32 v217, v201
    v_lshlrev_b32_e64 v204, 16, v182
    v_fma_f32 v203, v203, v243, v247
    v_mfma_f32_32x32x16_bf16 v[96:111], a[212:215], a[184:187], v[96:111]
    s_waitcnt lgkmcnt(3)
    ds_read_b128 a[200:203], v3 offset:9872
    buffer_load_dwordx4 a[140:143], v2, s[48:51], s76 offen offset:3072 sc1
    v_exp_f32 v218, v202
    v_fma_f32 v216, v216, s64, s64
    v_and_b32 v205, s78, v182
    v_fma_f32 v204, v204, v240, v244
    v_mfma_f32_32x32x16_bf16 v[80:95], a[216:219], a[188:191], v[80:95]
    s_waitcnt lgkmcnt(3)
    ds_read_b128 a[204:207], v3 offset:12048
    v_exp_f32 v219, v203
    v_fma_f32 v217, v217, s64, s64
    v_rcp_f32 v216, v216
    v_lshlrev_b32 v206, 16, v183
    v_fma_f32 v205, v205, v241, v245
    v_mfma_f32_32x32x16_bf16 v[144:159], a[220:223], a[188:191], v[144:159]
    s_waitcnt lgkmcnt(3)
    ds_read_b128 a[208:211], v3 offset:8784
    s_add_u32 s76, s76, 4096
    buffer_load_dwordx4 a[144:147], v2, s[48:51], s76 offen offset:0 sc1
    v_exp_f32 v220, v204
    v_fma_f32 v218, v218, s64, s64
    v_mfma_f32_32x32x16_bf16 v[48:63], a[192:195], a[0:3], v[48:63]
    s_waitcnt lgkmcnt(3)
    ds_read_b128 a[212:215], v3 offset:10960
    v_rcp_f32 v217, v217
    v_and_b32 v207, s78, v183
    v_fma_f32 v206, v206, v242, v246
    v_exp_f32 v221, v205
    v_fma_f32 v219, v219, s64, s64
    v_mfma_f32_32x32x16_bf16 v[112:127], a[196:199], a[0:3], v[112:127]
    s_waitcnt lgkmcnt(3)
    ds_read_b128 a[216:219], v3 offset:10416
    buffer_load_dwordx4 a[148:151], v2, s[48:51], s76 offen offset:1024 sc1
    v_mul_f32 v200, v200, v216
    v_rcp_f32 v218, v218
    v_lshlrev_b32 v196, 16, v166
    v_fma_f32 v207, v207, v243, v247
    v_mfma_f32_32x32x16_bf16 v[64:79], a[200:203], a[4:7], v[64:79]
    s_waitcnt lgkmcnt(3)
    ds_read_b128 a[220:223], v3 offset:12592
    v_exp_f32 v222, v206
    v_fma_f32 v220, v220, s64, s64
    v_mul_f32 v201, v201, v217
    v_rcp_f32 v219, v219
    v_and_b32 v197, s78, v166
    v_mfma_f32_32x32x16_bf16 v[128:143], a[204:207], a[4:7], v[128:143]
    s_waitcnt lgkmcnt(3)
    ds_read_b128 a[192:195], v4 offset:9328
    buffer_load_dwordx4 a[152:155], v2, s[48:51], s76 offen offset:2048 sc1
    v_fma_f32 v196, v196, v240, v244
    v_exp_f32_e64 v223, v207
    v_fma_f32 v221, v221, s64, s64
    v_mul_f32 v202, v202, v218
    v_mfma_f32_32x32x16_bf16 v[32:47], a[208:211], a[8:11], v[32:47]
    s_waitcnt lgkmcnt(3)
    ds_read_b128 a[196:199], v4 offset:11504
    v_rcp_f32 v220, v220
    v_lshlrev_b32 v198, 16, v167
    v_fma_f32 v197, v197, v241, v245
    v_exp_f32_e64 v216, v196
    v_fma_f32 v222, v222, s64, s64
    v_mfma_f32_32x32x16_bf16 v[96:111], a[212:215], a[8:11], v[96:111]
    s_waitcnt lgkmcnt(3)
    ds_read_b128 a[200:203], v4 offset:9872
    buffer_load_dwordx4 a[156:159], v2, s[48:51], s76 offen offset:3072 sc1
    v_mul_f32 v203, v203, v219
    v_rcp_f32 v221, v221
    v_and_b32_e64 v199, s78, v167
    v_fma_f32 v198, v198, v242, v246
    v_mfma_f32_32x32x16_bf16 v[80:95], a[216:219], a[12:15], v[80:95]
    s_waitcnt lgkmcnt(3)
    ds_read_b128 a[204:207], v4 offset:12048
    v_exp_f32 v217, v197
    v_fma_f32 v223, v223, s64, s64
    v_mul_f32 v204, v204, v220
    v_rcp_f32_e64 v222, v222
    v_lshlrev_b32 v208, 16, v190
    v_mfma_f32_32x32x16_bf16 v[144:159], a[220:223], a[12:15], v[144:159]
    s_waitcnt lgkmcnt(3)
    ds_read_b128 a[208:211], v4 offset:8784
    s_add_u32 s76, s76, 4096
    buffer_load_dwordx4 a[160:163], v2, s[48:51], s76 offen offset:0 sc1
    v_fma_f32 v199, v199, v243, v247
    v_exp_f32_e64 v218, v198
    v_fma_f32 v216, v216, s64, s64
    v_mfma_f32_32x32x16_bf16 v[48:63], a[192:195], a[16:19], v[48:63]
    s_waitcnt lgkmcnt(3)
    ds_read_b128 a[212:215], v4 offset:10960
    buffer_load_dwordx4 a[164:167], v2, s[48:51], s76 offen offset:1024 sc1
    v_mul_f32 v205, v205, v221
    v_rcp_f32 v223, v223
    v_and_b32_e64 v209, s78, v190
    v_fma_f32 v208, v208, v240, v244
    v_mfma_f32_32x32x16_bf16 v[112:127], a[196:199], a[16:19], v[112:127]
    s_waitcnt lgkmcnt(3)
    ds_read_b128 a[216:219], v4 offset:10416
    v_exp_f32 v219, v199
    v_fma_f32 v217, v217, s64, s64
    v_mul_f32 v206, v206, v222
    v_rcp_f32_e64 v216, v216
    v_lshlrev_b32 v210, 16, v191
    v_mfma_f32_32x32x16_bf16 v[64:79], a[200:203], a[20:23], v[64:79]
    s_waitcnt lgkmcnt(3)
    ds_read_b128 a[220:223], v4 offset:12592
    buffer_load_dwordx4 a[168:171], v2, s[48:51], s76 offen offset:2048 sc1
    v_fma_f32 v209, v209, v241, v245
    v_exp_f32 v220, v208
    v_fma_f32 v218, v218, s64, s64
    v_mul_f32 v207, v207, v223
    v_mfma_f32_32x32x16_bf16 v[128:143], a[204:207], a[20:23], v[128:143]
    s_waitcnt lgkmcnt(3)
    ds_read_b128 a[192:195], v3 offset:9312
    v_rcp_f32 v217, v217
    v_and_b32_e64 v211, s78, v191
    v_fma_f32 v210, v210, v242, v246
    v_exp_f32 v221, v209
    v_fma_f32 v219, v219, s64, s64
    v_mfma_f32_32x32x16_bf16 v[32:47], a[208:211], a[24:27], v[32:47]
    s_waitcnt lgkmcnt(3)
    ds_read_b128 a[196:199], v3 offset:11488
    buffer_load_dwordx4 a[172:175], v2, s[48:51], s76 offen offset:3072 sc1
    v_fma_f32 v248, v196, v216, v200
    v_fma_f32 v250, -v196, v216, v200
    v_rcp_f32_e64 v218, v218
    v_fma_f32 v252, -v196, v216, v204
    v_mfma_f32_32x32x16_bf16 v[96:111], a[212:215], a[24:27], v[96:111]
    s_waitcnt vmcnt(36) lgkmcnt(3)
    ds_read_b128 a[200:203], v3 offset:9856
    v_lshlrev_b32 v192, 16, v230
    v_fma_f32 v211, v211, v243, v247
    v_exp_f32_e64 v222, v210
    v_fma_f32 v220, v220, s64, s64
    v_fma_f32 v249, v197, v217, v201
    v_fma_f32 v251, -v197, v217, v201
    v_mfma_f32_32x32x16_bf16 v[80:95], a[216:219], a[28:31], v[80:95]
    s_waitcnt lgkmcnt(3)
    ds_read_b128 a[204:207], v3 offset:12032
    s_add_u32 s76, s76, 4096
    buffer_load_dwordx4 a[176:179], v2, s[48:51], s76 offen offset:0 sc1
    v_rcp_f32 v219, v219
    v_fma_f32 v253, -v197, v217, v205
    v_cvt_pk_bf16_f32 v248, v248, v249
    v_mfma_f32_32x32x16_bf16 v[144:159], a[220:223], a[28:31], v[144:159]
    s_waitcnt vmcnt(36) lgkmcnt(3)
    ds_read_b128 a[208:211], v3 offset:8768
    v_cvt_pk_bf16_f32 v250, v250, v251
    v_cvt_pk_bf16_f32 v252, v252, v253
    v_and_b32 v193, s78, v230
    v_fma_f32 v192, v192, v240, v244
    v_exp_f32_e64 v223, v211
    v_fma_f32 v221, v221, s64, s64
    v_mfma_f32_32x32x16_bf16 v[48:63], a[192:195], a[32:35], v[48:63]
    s_waitcnt lgkmcnt(3)
    ds_read_b128 a[212:215], v3 offset:10944
    buffer_load_dwordx4 a[180:183], v2, s[48:51], s76 offen offset:1024 sc1
    v_fma_f32 v249, v198, v218, v202
    v_fma_f32 v251, -v198, v218, v202
    v_rcp_f32 v220, v220
    v_fma_f32 v253, -v198, v218, v206
    v_mfma_f32_32x32x16_bf16 v[112:127], a[196:199], a[32:35], v[112:127]
    s_waitcnt vmcnt(36) lgkmcnt(3)
    ds_read_b128 a[216:219], v3 offset:10400
    buffer_load_dwordx4 a[184:187], v2, s[48:51], s76 offen offset:2048 sc1
    v_lshlrev_b32 v194, 16, v231
    v_fma_f32 v193, v193, v241, v245
    v_exp_f32 v216, v192
    v_fma_f32 v222, v222, s64, s64
    v_mfma_f32_32x32x16_bf16 v[64:79], a[200:203], a[36:39], v[64:79]
    s_waitcnt lgkmcnt(3)
    ds_read_b128 a[220:223], v3 offset:12576
    v_fma_f32 v30, v199, v219, v203
    v_fma_f32 v31, -v199, v219, v203
    v_rcp_f32_e64 v221, v221
    v_fma_f32 v29, -v199, v219, v207
    v_cvt_pk_bf16_f32 v249, v249, v30
    v_cvt_pk_bf16_f32 v251, v251, v31
    v_mfma_f32_32x32x16_bf16 v[128:143], a[204:207], a[36:39], v[128:143]
    s_waitcnt vmcnt(36) lgkmcnt(3)
    ds_read_b128 a[192:195], v4 offset:9312
    buffer_load_dwordx4 a[188:191], v2, s[48:51], s76 offen offset:3072 sc1
    ds_write_b64 v7, v[248:249] offset:13696
    ds_write_b64 v7, v[250:251] offset:14240
    v_mfma_f32_32x32x16_bf16 v[32:47], a[208:211], a[40:43], v[32:47]
    s_waitcnt lgkmcnt(5)
    ds_read_b128 a[196:199], v4 offset:11488
    v_cvt_pk_bf16_f32 v253, v253, v29
    v_and_b32_e64 v195, s78, v231
    v_fma_f32 v194, v194, v242, v246
    v_exp_f32_e64 v217, v193
    v_fma_f32 v223, v223, s64, s64
    v_fma_f32 v174, -v208, v220, v200
    v_mfma_f32_32x32x16_bf16 v[96:111], a[212:215], a[40:43], v[96:111]
    s_waitcnt vmcnt(36) lgkmcnt(5)
    ds_read_b128 a[200:203], v4 offset:9856
    ds_write_b64 v7, v[252:253] offset:14784
    v_fma_f32 v182, v208, v220, v204
    v_rcp_f32_e64 v222, v222
    v_fma_f32 v166, v208, v220, -v204
    v_mfma_f32_32x32x16_bf16 v[80:95], a[216:219], a[44:47], v[80:95]
    s_waitcnt lgkmcnt(6)
    ds_read_b128 a[204:207], v4 offset:12032
    v_lshlrev_b32 v212, 16, v238
    v_fma_f32 v195, v195, v243, v247
    v_exp_f32 v218, v194
    v_fma_f32 v216, v216, s64, v254
    v_fma_f32 v175, -v209, v221, v201
    v_fma_f32 v183, v209, v221, v205
    v_mfma_f32_32x32x16_bf16 v[144:159], a[220:223], a[44:47], v[144:159]
    s_waitcnt vmcnt(35) lgkmcnt(6)
    ds_read_b128 a[208:211], v4 offset:8768
    v_rcp_f32 v223, v223
    v_fma_f32 v167, v209, v221, -v205
    v_cvt_pk_bf16_f32 v174, v174, v175
    v_cvt_pk_bf16_f32 v182, v182, v183
    v_cvt_pk_bf16_f32 v166, v166, v167
    v_and_b32 v213, s78, v238
    v_mfma_f32_32x32x16_bf16 v[48:63], a[192:195], a[48:51], v[48:63]
    s_waitcnt lgkmcnt(4)
    ds_read_b128 a[212:215], v4 offset:10944
    v_fma_f32 v212, v212, v240, v244
    v_exp_f32_e64 v219, v195
    v_fma_f32 v217, v217, s64, v254
    v_fma_f32 v175, -v210, v222, v202
    v_fma_f32 v183, v210, v222, v206
    v_mfma_f32_32x32x16_bf16 v[112:127], a[196:199], a[48:51], v[112:127]
    s_waitcnt vmcnt(34) lgkmcnt(4)
    ds_read_b128 a[216:219], v4 offset:10400
    v_rcp_f32 v216, v216
    v_fma_f32 v167, v210, v222, -v206
    v_lshlrev_b32 v214, 16, v239
    v_fma_f32 v213, v213, v241, v245
    v_mfma_f32_32x32x16_bf16 v[64:79], a[200:203], a[52:55], v[64:79]
    s_waitcnt lgkmcnt(3)
    ds_read_b128 a[220:223], v4 offset:12576
    v_exp_f32_e64 v220, v212
    v_fma_f32 v218, v218, s64, v254
    v_fma_f32 v30, -v211, v223, v203
    v_fma_f32 v31, v211, v223, v207
    v_mfma_f32_32x32x16_bf16 v[128:143], a[204:207], a[52:55], v[128:143]
    s_waitcnt vmcnt(33) lgkmcnt(3)
    ds_read_b128 a[192:195], v3 offset:9344
    v_rcp_f32 v217, v217
    v_fma_f32 v29, v211, v223, -v207
    v_cvt_pk_bf16_f32 v175, v175, v30
    v_cvt_pk_bf16_f32 v183, v183, v31
    v_cvt_pk_bf16_f32 v167, v167, v29
    v_mfma_f32_32x32x16_bf16 v[32:47], a[208:211], a[56:59], v[32:47]
    s_waitcnt lgkmcnt(3)
    ds_read_b128 a[196:199], v3 offset:11520
    ds_write_b64 v7, v[174:175] offset:15328
    ds_write_b64 v7, v[182:183] offset:15872
    v_mfma_f32_32x32x16_bf16 v[96:111], a[212:215], a[56:59], v[96:111]
    s_waitcnt vmcnt(32) lgkmcnt(5)
    ds_read_b128 a[200:203], v3 offset:9888
    ds_write_b64 v7, v[166:167] offset:16416
    v_and_b32 v215, s78, v239
    v_fma_f32 v214, v214, v242, v246
    v_mfma_f32_32x32x16_bf16 v[80:95], a[216:219], a[60:63], v[80:95]
    s_waitcnt lgkmcnt(6)
    ds_read_b128 a[204:207], v3 offset:12064
    v_exp_f32 v221, v213
    v_fma_f32 v219, v219, s64, v254
    v_fma_f32 v190, v192, v216, -v200
    v_rcp_f32 v218, v218
    v_mfma_f32_32x32x16_bf16 v[144:159], a[220:223], a[60:63], v[144:159]
    s_waitcnt vmcnt(31) lgkmcnt(6)
    ds_read_b128 a[208:211], v3 offset:8800
    v_fma_f32 v215, v215, v243, v247
    v_exp_f32 v222, v214
    v_fma_f32 v220, v220, s64, v255
    v_fma_f32 v191, v193, v217, -v201
    v_cvt_pk_bf16_f32 v190, v190, v191
    v_mfma_f32_32x32x16_bf16 v[48:63], a[192:195], a[64:67], v[48:63]
    s_waitcnt lgkmcnt(6)
    ds_read_b128 a[212:215], v3 offset:10976
    v_rcp_f32 v219, v219
    v_exp_f32_e64 v223, v215
    v_fma_f32 v221, v221, s64, v255
    v_fma_f32 v191, v194, v218, -v202
    v_mfma_f32_32x32x16_bf16 v[112:127], a[196:199], a[64:67], v[112:127]
    s_waitcnt vmcnt(30) lgkmcnt(4)
    ds_read_b128 a[216:219], v3 offset:10432
    v_rcp_f32 v220, v220
    v_fma_f32 v222, v222, s64, v255
    v_fma_f32 v30, v195, v219, -v203
    v_cvt_pk_bf16_f32 v191, v191, v30
    v_mfma_f32_32x32x16_bf16 v[64:79], a[200:203], a[68:71], v[64:79]
    s_waitcnt lgkmcnt(3)
    ds_read_b128 a[220:223], v3 offset:12608
    v_rcp_f32 v221, v221
    v_fma_f32 v223, v223, s64, v255
    v_fma_f32 v248, v212, v220, -v204
    v_mfma_f32_32x32x16_bf16 v[128:143], a[204:207], a[68:71], v[128:143]
    s_waitcnt vmcnt(29) lgkmcnt(3)
    ds_read_b128 a[192:195], v4 offset:9344
    ds_write_b64 v7, v[190:191] offset:13152
    v_rcp_f32 v222, v222
    v_mfma_f32_32x32x16_bf16 v[32:47], a[208:211], a[72:75], v[32:47]
    s_waitcnt lgkmcnt(4)
    ds_read_b128 a[196:199], v4 offset:11520
    v_fma_f32 v249, v213, v221, -v205
    v_cvt_pk_bf16_f32 v248, v248, v249
    v_rcp_f32 v223, v223
    v_fma_f32 v249, v214, v222, -v206
    v_mfma_f32_32x32x16_bf16 v[96:111], a[212:215], a[72:75], v[96:111]
    s_waitcnt vmcnt(28) lgkmcnt(4)
    ds_read_b128 a[200:203], v4 offset:9888
    v_fma_f32 v30, v215, v223, -v207
    v_cvt_pk_bf16_f32 v249, v249, v30
    v_mfma_f32_32x32x16_bf16 v[80:95], a[216:219], a[76:79], v[80:95]
    s_waitcnt lgkmcnt(4)
    ds_read_b128 a[204:207], v4 offset:12064
    ds_write_b64 v7, v[248:249] offset:16960
    v_mfma_f32_32x32x16_bf16 v[144:159], a[220:223], a[76:79], v[144:159]
    s_waitcnt vmcnt(27) lgkmcnt(5)
    ds_read_b128 a[208:211], v4 offset:8800
    v_mfma_f32_32x32x16_bf16 v[48:63], a[192:195], a[80:83], v[48:63]
    s_waitcnt lgkmcnt(4)
    ds_read_b128 a[212:215], v4 offset:10976
    v_mfma_f32_32x32x16_bf16 v[112:127], a[196:199], a[80:83], v[112:127]
    s_waitcnt vmcnt(26) lgkmcnt(2)
    s_barrier
    ds_read_b128 a[216:219], v4 offset:10432
    v_mfma_f32_32x32x16_bf16 v[64:79], a[200:203], a[84:87], v[64:79]
    ds_read_b128 a[220:223], v4 offset:12608
    v_mfma_f32_32x32x16_bf16 v[128:143], a[204:207], a[84:87], v[128:143]
    s_waitcnt vmcnt(25) lgkmcnt(3)
    ds_read_b128 a[192:195], v3 offset:13712
    v_mfma_f32_32x32x16_bf16 v[32:47], a[208:211], a[88:91], v[32:47]
    s_waitcnt lgkmcnt(3)
    ds_read_b128 a[196:199], v4 offset:13712
    v_mfma_f32_32x32x16_bf16 v[96:111], a[212:215], a[88:91], v[96:111]
    s_waitcnt vmcnt(24) lgkmcnt(3)
    ds_read_b128 a[200:203], v3 offset:13696
    v_mfma_f32_32x32x16_bf16 v[80:95], a[216:219], a[92:95], v[80:95]
    s_waitcnt lgkmcnt(3)
    ds_read_b128 a[204:207], v4 offset:13696
    v_mfma_f32_32x32x16_bf16 v[144:159], a[220:223], a[92:95], v[144:159]
    s_waitcnt vmcnt(23) lgkmcnt(3)
    ds_read_b128 a[208:211], v3 offset:13728
    v_mfma_f32_32x32x16_bf16 v[48:63], a[192:195], a[96:99], v[48:63]
    s_waitcnt vmcnt(22) lgkmcnt(3)
    ds_read_b128 a[212:215], v4 offset:13728
    v_mfma_f32_32x32x16_bf16 v[48:63], a[196:199], a[100:103], v[48:63]
    s_waitcnt vmcnt(21) lgkmcnt(3)
    ds_read_b128 a[216:219], v3 offset:14256
    v_mfma_f32_32x32x16_bf16 v[48:63], a[200:203], a[104:107], v[48:63]
    s_waitcnt vmcnt(20) lgkmcnt(3)
    ds_read_b128 a[220:223], v4 offset:14256
    v_mfma_f32_32x32x16_bf16 v[48:63], a[204:207], a[108:111], v[48:63]
    s_waitcnt vmcnt(19) lgkmcnt(3)
    ds_read_b128 a[192:195], v3 offset:14240
    v_mfma_f32_32x32x16_bf16 v[48:63], a[208:211], a[112:115], v[48:63]
    s_waitcnt vmcnt(18) lgkmcnt(3)
    ds_read_b128 a[196:199], v4 offset:14240
    v_mfma_f32_32x32x16_bf16 v[48:63], a[212:215], a[116:119], v[48:63]
    s_waitcnt vmcnt(17) lgkmcnt(3)
    ds_read_b128 a[200:203], v3 offset:14272
    v_mfma_f32_32x32x16_bf16 v[64:79], a[216:219], a[120:123], v[64:79]
    s_waitcnt vmcnt(16) lgkmcnt(3)
    ds_read_b128 a[204:207], v4 offset:14272
    v_mfma_f32_32x32x16_bf16 v[64:79], a[220:223], a[124:127], v[64:79]
    s_waitcnt vmcnt(15) lgkmcnt(3)
    ds_read_b128 a[208:211], v3 offset:13168
    v_fmac_f32 v80, 0.5, v48
    v_fmac_f32 v81, 0.5, v49
    v_fmac_f32 v82, 0.5, v50
    v_fmac_f32 v83, 0.5, v51
    v_fmac_f32 v84, 0.5, v52
    v_fmac_f32 v85, 0.5, v53
    v_mfma_f32_32x32x16_bf16 v[64:79], a[192:195], a[128:131], v[64:79]
    s_waitcnt vmcnt(14) lgkmcnt(3)
    ds_read_b128 a[212:215], v4 offset:13168
    v_fmac_f32 v86, 0.5, v54
    v_fmac_f32 v87, 0.5, v55
    v_fmac_f32 v88, 0.5, v56
    v_fmac_f32 v89, 0.5, v57
    v_fmac_f32 v90, 0.5, v58
    v_fmac_f32 v91, 0.5, v59
    v_mfma_f32_32x32x16_bf16 v[64:79], a[196:199], a[132:135], v[64:79]
    s_waitcnt vmcnt(13) lgkmcnt(3)
    ds_read_b128 a[216:219], v3 offset:13152
    v_fmac_f32 v92, 0.5, v60
    v_fmac_f32 v93, 0.5, v61
    v_fmac_f32 v94, 0.5, v62
    v_fmac_f32 v95, 0.5, v63
    v_mfma_f32_32x32x16_bf16 v[64:79], a[200:203], a[136:139], v[64:79]
    s_waitcnt vmcnt(12) lgkmcnt(3)
    ds_read_b128 a[220:223], v4 offset:13152
    v_mfma_f32_32x32x16_bf16 v[64:79], a[204:207], a[140:143], v[64:79]
    s_waitcnt vmcnt(11) lgkmcnt(3)
    ds_read_b128 a[192:195], v3 offset:13184
    v_mfma_f32_32x32x16_bf16 v[32:47], a[208:211], a[144:147], v[32:47]
    s_waitcnt vmcnt(10) lgkmcnt(3)
    ds_read_b128 a[196:199], v4 offset:13184
    v_mfma_f32_32x32x16_bf16 v[32:47], a[212:215], a[148:151], v[32:47]
    s_waitcnt vmcnt(9) lgkmcnt(3)
    ds_read_b128 a[200:203], v3 offset:14800
    v_fmac_f32 v80, -0.5, v64
    v_fmac_f32 v81, -0.5, v65
    v_fmac_f32 v82, -0.5, v66
    v_fmac_f32 v83, -0.5, v67
    v_fmac_f32 v84, -0.5, v68
    v_fmac_f32 v85, -0.5, v69
    v_mfma_f32_32x32x16_bf16 v[32:47], a[216:219], a[152:155], v[32:47]
    s_waitcnt vmcnt(8) lgkmcnt(3)
    ds_read_b128 a[204:207], v4 offset:14800
    v_fmac_f32 v86, -0.5, v70
    v_fmac_f32 v87, -0.5, v71
    v_fmac_f32 v88, -0.5, v72
    v_fmac_f32 v89, -0.5, v73
    v_fmac_f32 v90, -0.5, v74
    v_fmac_f32 v91, -0.5, v75
    v_mfma_f32_32x32x16_bf16 v[32:47], a[220:223], a[156:159], v[32:47]
    s_waitcnt vmcnt(7) lgkmcnt(3)
    ds_read_b128 a[208:211], v3 offset:14784
    v_fmac_f32 v92, -0.5, v76
    v_fmac_f32 v93, -0.5, v77
    v_fmac_f32 v94, -0.5, v78
    v_fmac_f32_e64 v95, -0.5, v79
    v_mfma_f32_32x32x16_bf16 v[32:47], a[192:195], a[160:163], v[32:47]
    s_waitcnt vmcnt(6) lgkmcnt(3)
    ds_read_b128 a[212:215], v4 offset:14784
    v_mfma_f32_32x32x16_bf16 v[32:47], a[196:199], a[164:167], v[32:47]
    s_waitcnt vmcnt(5) lgkmcnt(3)
    ds_read_b128 a[216:219], v3 offset:14816
    v_mfma_f32_32x32x16_bf16 v[80:95], a[200:203], a[168:171], v[80:95]
    s_waitcnt vmcnt(4) lgkmcnt(3)
    ds_read_b128 a[220:223], v4 offset:14816
    v_mfma_f32_32x32x16_bf16 v[80:95], a[204:207], a[172:175], v[80:95]
    s_waitcnt vmcnt(3) lgkmcnt(3)
    ds_read_b128 a[192:195], v3 offset:15888
    v_fmac_f32 v32, 0.5, v48
    v_fmac_f32 v33, 0.5, v49
    v_fmac_f32 v34, 0.5, v50
    v_fmac_f32 v35, 0.5, v51
    v_fmac_f32 v36, 0.5, v52
    v_fmac_f32 v37, 0.5, v53
    v_fmac_f32 v38, 0.5, v54
    v_mfma_f32_32x32x16_bf16 v[80:95], a[208:211], a[176:179], v[80:95]
    s_waitcnt vmcnt(2) lgkmcnt(3)
    ds_read_b128 a[196:199], v4 offset:15888
    v_fmac_f32 v39, 0.5, v55
    v_fmac_f32 v40, 0.5, v56
    v_fmac_f32 v41, 0.5, v57
    v_fmac_f32 v42, 0.5, v58
    v_fmac_f32 v43, 0.5, v59
    v_fmac_f32 v44, 0.5, v60
    v_fmac_f32_e64 v45, 0.5, v61
    v_mfma_f32_32x32x16_bf16 v[80:95], a[212:215], a[180:183], v[80:95]
    s_waitcnt vmcnt(1) lgkmcnt(3)
    ds_read_b128 a[200:203], v3 offset:15872
    v_fmac_f32 v46, 0.5, v62
    v_fmac_f32 v47, 0.5, v63
    v_fmac_f32 v32, 0.5, v64
    v_fmac_f32 v33, 0.5, v65
    v_fmac_f32 v34, 0.5, v66
    v_fmac_f32 v35, 0.5, v67
    v_fmac_f32_e64 v36, 0.5, v68
    v_mfma_f32_32x32x16_bf16 v[80:95], a[216:219], a[184:187], v[80:95]
    s_waitcnt vmcnt(0) lgkmcnt(3)
    ds_read_b128 a[204:207], v4 offset:15872
    v_fmac_f32 v37, 0.5, v69
    v_fmac_f32 v38, 0.5, v70
    v_fmac_f32 v39, 0.5, v71
    v_fmac_f32 v40, 0.5, v72
    v_fmac_f32 v41, 0.5, v73
    v_fmac_f32 v42, 0.5, v74
    v_fmac_f32 v43, 0.5, v75
    v_mfma_f32_32x32x16_bf16 v[80:95], a[220:223], a[188:191], v[80:95]
    s_waitcnt lgkmcnt(3)
    ds_read_b128 a[208:211], v3 offset:15904
    v_fmac_f32 v44, 0.5, v76
    v_fmac_f32 v45, 0.5, v77
    v_fmac_f32 v46, 0.5, v78
    v_fmac_f32 v47, 0.5, v79
    v_cvt_pk_bf16_f32 v160, v32, v33
    v_cvt_pk_bf16_f32 v161, v34, v35
    v_cvt_pk_bf16_f32 v162, v36, v37
    v_mfma_f32_32x32x16_bf16 v[112:127], a[192:195], a[96:99], v[112:127]
    s_waitcnt lgkmcnt(3)
    ds_read_b128 a[212:215], v4 offset:15904
    v_cvt_pk_bf16_f32 v163, v38, v39
    v_cvt_pk_bf16_f32 v164, v40, v41
    v_cvt_pk_bf16_f32 v165, v42, v43
    v_cvt_pk_bf16_f32 v166, v44, v45
    v_cvt_pk_bf16_f32 v167, v46, v47
    v_mfma_f32_32x32x16_bf16 v[112:127], a[196:199], a[100:103], v[112:127]
    s_waitcnt lgkmcnt(3)
    ds_read_b128 a[216:219], v3 offset:16432
    ds_write_b64 v19, v[160:161] offset:0
    ds_write_b64 v19, v[162:163] offset:16
    v_mfma_f32_32x32x16_bf16 v[112:127], a[200:203], a[104:107], v[112:127]
    s_waitcnt lgkmcnt(5)
    ds_read_b128 a[220:223], v4 offset:16432
    ds_write_b64 v19, v[164:165] offset:32
    ds_write_b64 v19, v[166:167] offset:48
    ds_read_b128 v[168:171], v0 offset:0
    v_mfma_f32_32x32x16_bf16 v[112:127], a[204:207], a[108:111], v[112:127]
    s_waitcnt lgkmcnt(8)
    ds_read_b128 a[192:195], v3 offset:16416
    ds_read_b128 v[172:175], v0 offset:1280
    v_mfma_f32_32x32x16_bf16 v[112:127], a[208:211], a[112:115], v[112:127]
    s_waitcnt lgkmcnt(9)
    ds_read_b128 a[196:199], v4 offset:16416
    v_cvt_pk_bf16_f32 v176, v80, v81
    v_cvt_pk_bf16_f32 v177, v82, v83
    v_cvt_pk_bf16_f32 v178, v84, v85
    v_cvt_pk_bf16_f32 v179, v86, v87
    v_cvt_pk_bf16_f32 v180, v88, v89
    v_cvt_pk_bf16_f32 v181, v90, v91
    v_cvt_pk_bf16_f32 v182, v92, v93
    v_mfma_f32_32x32x16_bf16 v[112:127], a[212:215], a[116:119], v[112:127]
    s_waitcnt lgkmcnt(9)
    ds_read_b128 a[200:203], v3 offset:16448
    v_cvt_pk_bf16_f32 v183, v94, v95
    v_mfma_f32_32x32x16_bf16 v[128:143], a[216:219], a[120:123], v[128:143]
    s_waitcnt lgkmcnt(4)
    ds_read_b128 a[204:207], v4 offset:16448
    buffer_store_dwordx4 v[168:171], v5, s[44:47], 0 offen offset:0 sc1 nt
    v_mfma_f32_32x32x16_bf16 v[128:143], a[220:223], a[124:127], v[128:143]
    s_waitcnt lgkmcnt(3)
    ds_read_b128 a[208:211], v3 offset:16976
    buffer_store_dwordx4 v[172:175], v5, s[44:47], s63 offen offset:0 sc1 nt
    ds_write_b64 v19, v[176:177] offset:2560
    v_mfma_f32_32x32x16_bf16 v[128:143], a[192:195], a[128:131], v[128:143]
    s_waitcnt lgkmcnt(4)
    ds_read_b128 a[212:215], v4 offset:16976
    ds_write_b64 v19, v[178:179] offset:2576
    ds_write_b64 v19, v[180:181] offset:2592
    ds_write_b64 v19, v[182:183] offset:2608
    v_mfma_f32_32x32x16_bf16 v[128:143], a[196:199], a[132:135], v[128:143]
    s_waitcnt lgkmcnt(7)
    ds_read_b128 a[216:219], v3 offset:16960
    ds_read_b128 v[184:187], v0 offset:2560
    ds_read_b128 v[188:191], v0 offset:3840
    v_mfma_f32_32x32x16_bf16 v[128:143], a[200:203], a[136:139], v[128:143]
L_hop6:
    s_cbranch_execz L_hop_ret
    s_waitcnt lgkmcnt(9)
    ds_read_b128 a[220:223], v4 offset:16960
    v_fmac_f32 v144, 0.5, v112
    v_fmac_f32 v145, 0.5, v113
    v_fmac_f32 v146, 0.5, v114
    v_fmac_f32 v147, 0.5, v115
    v_fmac_f32 v148, 0.5, v116
    v_fmac_f32 v149, 0.5, v117
    v_fmac_f32 v150, 0.5, v118
    v_fmac_f32 v151, 0.5, v119
    v_fmac_f32 v152, 0.5, v120
    v_fmac_f32 v153, 0.5, v121
    v_fmac_f32 v154, 0.5, v122
    v_fmac_f32 v155, 0.5, v123
    v_fmac_f32 v156, 0.5, v124
    v_fmac_f32 v157, 0.5, v125
    v_fmac_f32 v158, 0.5, v126
    v_fmac_f32 v159, 0.5, v127
    v_mfma_f32_32x32x16_bf16 v[128:143], a[204:207], a[140:143], v[128:143]
    s_waitcnt lgkmcnt(9)
    ds_read_b128 a[192:195], v3 offset:16992
    v_mfma_f32_32x32x16_bf16 v[144:159], a[208:211], a[168:171], v[144:159]
    s_waitcnt lgkmcnt(3)
    ds_read_b128 a[196:199], v4 offset:16992
    buffer_store_dwordx4 v[184:187], v5, s[44:47], 0 offen offset:256 sc1 nt
    v_mfma_f32_32x32x16_bf16 v[144:159], a[212:215], a[172:175], v[144:159]
    s_waitcnt lgkmcnt(3)
    ds_read_b128 a[200:203], v3 offset:15344
    buffer_store_dwordx4 v[188:191], v5, s[44:47], s63 offen offset:256 sc1 nt
    v_fmac_f32 v96, 0.5, v112
    v_fmac_f32 v97, 0.5, v113
    v_fmac_f32 v98, 0.5, v114
    v_fmac_f32 v99, 0.5, v115
    v_fmac_f32 v100, 0.5, v116
    v_mfma_f32_32x32x16_bf16 v[144:159], a[216:219], a[176:179], v[144:159]
    s_waitcnt lgkmcnt(3)
    ds_read_b128 a[204:207], v4 offset:15344
    v_fmac_f32 v101, 0.5, v117
    v_fmac_f32 v102, 0.5, v118
    v_fmac_f32 v103, 0.5, v119
    v_fmac_f32 v104, 0.5, v120
    v_fmac_f32 v105, 0.5, v121
    v_fmac_f32 v106, 0.5, v122
    v_fmac_f32 v107, 0.5, v123
    v_fmac_f32 v108, 0.5, v124
    v_fmac_f32_e64 v109, 0.5, v125
    v_mfma_f32_32x32x16_bf16 v[144:159], a[220:223], a[180:183], v[144:159]
    s_waitcnt lgkmcnt(3)
    ds_read_b128 a[208:211], v3 offset:15328
    v_fmac_f32 v110, 0.5, v126
    v_fmac_f32_e64 v111, 0.5, v127
    v_mfma_f32_32x32x16_bf16 v[144:159], a[192:195], a[184:187], v[144:159]
    s_waitcnt lgkmcnt(3)
    ds_read_b128 a[212:215], v4 offset:15328
    v_fmac_f32 v96, 0.5, v128
    v_fmac_f32 v97, 0.5, v129
    v_fmac_f32 v98, 0.5, v130
    v_fmac_f32 v99, 0.5, v131
    v_fmac_f32 v100, 0.5, v132
    v_fmac_f32 v101, 0.5, v133
    v_fmac_f32 v102, 0.5, v134
    v_fmac_f32 v103, 0.5, v135
    v_fmac_f32 v104, 0.5, v136
    v_fmac_f32 v105, 0.5, v137
    v_fmac_f32 v106, 0.5, v138
    v_fmac_f32 v107, 0.5, v139
    v_fmac_f32 v108, 0.5, v140
    v_fmac_f32 v109, 0.5, v141
    v_fmac_f32 v110, 0.5, v142
    v_fmac_f32_e64 v111, 0.5, v143
    v_mfma_f32_32x32x16_bf16 v[144:159], a[196:199], a[188:191], v[144:159]
    s_waitcnt lgkmcnt(3)
    ds_read_b128 a[216:219], v3 offset:15360
    v_mfma_f32_32x32x16_bf16 v[96:111], a[200:203], a[144:147], v[96:111]
    s_waitcnt lgkmcnt(3)
    ds_read_b128 a[220:223], v4 offset:15360
    v_mfma_f32_32x32x16_bf16 v[96:111], a[204:207], a[148:151], v[96:111]
    s_waitcnt lgkmcnt(3)
    v_fmac_f32 v144, -0.5, v128
    v_fmac_f32 v145, -0.5, v129
    v_fmac_f32 v146, -0.5, v130
    v_fmac_f32 v147, -0.5, v131
    v_fmac_f32 v148, -0.5, v132
    v_fmac_f32 v149, -0.5, v133
    v_fmac_f32 v150, -0.5, v134
    v_fmac_f32 v151, -0.5, v135
    v_fmac_f32 v152, -0.5, v136
    v_fmac_f32 v153, -0.5, v137
    v_fmac_f32 v154, -0.5, v138
    v_mfma_f32_32x32x16_bf16 v[96:111], a[208:211], a[152:155], v[96:111]
    s_waitcnt lgkmcnt(2)
    v_fmac_f32 v155, -0.5, v139
    v_fmac_f32 v156, -0.5, v140
    v_fmac_f32 v157, -0.5, v141
    v_fmac_f32 v158, -0.5, v142
    v_fmac_f32_e64 v159, -0.5, v143
    v_cvt_pk_bf16_f32 v192, v144, v145
    v_cvt_pk_bf16_f32 v193, v146, v147
    v_cvt_pk_bf16_f32 v194, v148, v149
    v_cvt_pk_bf16_f32 v195, v150, v151
    v_cvt_pk_bf16_f32 v196, v152, v153
    v_mfma_f32_32x32x16_bf16 v[96:111], a[212:215], a[156:159], v[96:111]
    s_waitcnt lgkmcnt(1)
    v_cvt_pk_bf16_f32 v197, v154, v155
    v_cvt_pk_bf16_f32 v198, v156, v157
    v_cvt_pk_bf16_f32 v199, v158, v159
    v_mfma_f32_32x32x16_bf16 v[96:111], a[216:219], a[160:163], v[96:111]
    s_waitcnt lgkmcnt(0)
    ds_write_b64 v19, v[192:193] offset:7680
    ds_write_b64 v19, v[194:195] offset:7696
    ds_write_b64 v19, v[196:197] offset:7712
    v_mfma_f32_32x32x16_bf16 v[96:111], a[220:223], a[164:167], v[96:111]
    ds_write_b64 v19, v[198:199] offset:7728
    ds_read_b128 v[200:203], v0 offset:7680
    ds_read_b128 v[204:207], v0 offset:8960
    s_waitcnt lgkmcnt(1)
    buffer_store_dwordx4 v[200:203], v5, s[44:47], 0 offen offset:768 sc1 nt
    s_waitcnt lgkmcnt(0)
    buffer_store_dwordx4 v[204:207], v5, s[44:47], s63 offen offset:768 sc1 nt
    s_nop 9
    v_cvt_pk_bf16_f32 v208, v96, v97
    v_cvt_pk_bf16_f32 v209, v98, v99
    v_cvt_pk_bf16_f32 v210, v100, v101
    v_cvt_pk_bf16_f32 v211, v102, v103
    v_cvt_pk_bf16_f32 v212, v104, v105
    v_cvt_pk_bf16_f32 v213, v106, v107
    v_cvt_pk_bf16_f32 v214, v108, v109
    v_cvt_pk_bf16_f32 v215, v110, v111
    ds_write_b64 v19, v[208:209] offset:5120
    ds_write_b64 v19, v[210:211] offset:5136
    ds_write_b64 v19, v[212:213] offset:5152
    ds_write_b64 v19, v[214:215] offset:5168
    ds_read_b128 v[216:219], v0 offset:5120
    ds_read_b128 v[220:223], v0 offset:6400
    s_waitcnt lgkmcnt(1)
    buffer_store_dwordx4 v[216:219], v5, s[44:47], 0 offen offset:512 sc1 nt
    s_waitcnt lgkmcnt(0)
    buffer_store_dwordx4 v[220:223], v5, s[44:47], s63 offen offset:512 sc1 nt
    s_or_b32 s10, s7, s3
    s_cmp_eq_u32 s10, 0
    s_cbranch_scc0 L_noepoch
    s_add_u32 s10, s8, 1
    v_mov_b32 v24, s10
    s_lshl_b32 s11, s4, 8
    s_mov_b64 exec, 1
    buffer_store_dword v24, v17, s[48:51], s11 offen sc1
    s_mov_b64 exec, -1
L_noepoch:
L_end:
    s_endpgm
L_xc1_retry:
    s_add_u32 s67, s67, 1
    s_cmp_ge_u32 s67, 200000
    s_cbranch_scc1 L_xc1_done
    s_sleep 1
    buffer_load_dwordx4 v[128:131], v10, s[48:51], s0 offen sc1
    buffer_load_dwordx2 v[132:133], v10, s[48:51], s24 offen offset:8 sc1
    buffer_load_dwordx2 v[134:135], v10, s[48:51], s25 offen sc1
    s_waitcnt vmcnt(0)
    s_branch L_xc1
L_xc2_retry:
    s_add_u32 s67, s67, 1
    s_cmp_ge_u32 s67, 200000
    s_cbranch_scc1 L_xc2_done
    s_sleep 1
    buffer_load_dwordx4 v[128:131], v10, s[48:51], s0 offen sc1
    buffer_load_dwordx2 v[132:133], v10, s[48:51], s24 offen offset:8 sc1
    buffer_load_dwordx2 v[134:135], v10, s[48:51], s25 offen sc1
    s_waitcnt vmcnt(0)
    s_branch L_xc2
L_code_end:
.section .rodata,"a"
.p2align 6
.amdhsa_kernel standalone__adm_resblock__diffusion_kernel
  .amdhsa_next_free_vgpr 512
  .amdhsa_next_free_sgpr 102
  .amdhsa_accum_offset 256
  .amdhsa_group_segment_fixed_size 0
  .amdhsa_kernarg_size 96
  .amdhsa_user_sgpr_count 2
  .amdhsa_user_sgpr_kernarg_segment_ptr 1
  .amdhsa_system_sgpr_workgroup_id_x 1
  .amdhsa_float_denorm_mode_32 3
.end_amdhsa_kernel
```
